```python
import torch

def _softmax(x, axis=-1):
    return torch.softmax(x, dim=axis)

def _gelu(x):
    return torch.nn.functional.gelu(x, approximate='tanh')

def _silu(x):
    return torch.nn.functional.silu(x)

def _sigmoid(x):
    return torch.sigmoid(x)

def _layernorm(x, axis=-1, eps=1e-05):
    m = x.mean(dim=axis, keepdim=True)
    v = x.var(dim=axis, keepdim=True, unbiased=False)
    return (x - m) / torch.sqrt(v + eps)

def _scatter_add(tgt, idx, src, axis=0):
    return tgt.clone().index_add_(axis, idx, src)

def _segment_sum(src, seg, n):
    out = torch.zeros((n,) + src.shape[1:], dtype=src.dtype)
    return out.index_add_(0, seg, src)

def _pad(x, pw):
    flat = tuple((v for pair in reversed(pw) for v in pair))
    return torch.nn.functional.pad(x, flat)
kernel_name = 'concat_heads__memory_aug_recurrent_mem_tr__ssm_conv_h3__prompt'

def setup_inputs():

    _w = lambda a: (lambda t: t.to(torch.bfloat16) if t.is_floating_point() else t)(torch.as_tensor(a))

    def _A_setup():
        B, S, Dm = (1, 2048, 512)
        H, Dh = (32, 128)
        M, seg = (8, 32)
        seg = min(seg, S)
        S = S // seg * seg
        return {'x': _w((lambda *s: torch.randn(*s, dtype=torch.bfloat16) * 0.05)(B, S, Dm)), 'mem0': _w((lambda *s: torch.randn(*s, dtype=torch.bfloat16) * 0.4)(B, M, Dm)), 'Wq': _w((lambda *s: torch.randn(*s, dtype=torch.bfloat16) * 6.4)(Dm, H, Dh) * Dm ** (-0.5)), 'Wk': _w((lambda *s: torch.randn(*s, dtype=torch.bfloat16) * 6.4)(Dm, H, Dh) * Dm ** (-0.5)), 'Wv': _w((lambda *s: torch.randn(*s, dtype=torch.bfloat16) * 0.4)(Dm, H, Dh) * Dm ** (-0.5)), 'Wo': _w((lambda *s: torch.randn(*s, dtype=torch.bfloat16) * 0.4)(H, Dh, Dm) * (H * Dh) ** (-0.5)), 'seg_len': seg}
    _A_in = _A_setup()

    def _B_setup():
        B, S, D = (1, 2048, 512)
        ks = 4
        return {'q': _w((lambda *s: torch.randn(*s, dtype=torch.bfloat16) * 0.05)(B, S, D)), 'k': _w((lambda *s: torch.randn(*s, dtype=torch.bfloat16) * 0.4)(B, S, D)), 'v': _w((lambda *s: torch.randn(*s, dtype=torch.bfloat16) * 0.4)(B, S, D)), 'shift_k': _w((lambda *s: torch.randn(*s, dtype=torch.bfloat16) * 0.4)(D, ks) * 0.5), 'ssm_k': _w((lambda *s: torch.randn(*s, dtype=torch.bfloat16) * 0.4)(D, S) * (1.0 / S ** 0.5)), 'ssm_D': _w((lambda *s: torch.randn(*s, dtype=torch.bfloat16) * 0.4)(D))}
    _B_in = _B_setup()
    return {'A_x': _A_in['x'], 'A_mem0': _A_in['mem0'], 'A_Wq': _A_in['Wq'], 'A_Wk': _A_in['Wk'], 'A_Wv': _A_in['Wv'], 'A_Wo': _A_in['Wo'], 'A_seg_len': _A_in['seg_len'], 'B_q': _B_in['q'], 'B_k': _B_in['k'], 'B_v': _B_in['v'], 'B_shift_k': _B_in['shift_k'], 'B_ssm_k': _B_in['ssm_k'], 'B_ssm_D': _B_in['ssm_D']}

def reference(A_x, A_mem0, A_Wq, A_Wk, A_Wv, A_Wo, A_seg_len, B_q, B_k, B_v, B_shift_k, B_ssm_k, B_ssm_D):

    def _A_ref(x, mem0, Wq, Wk, Wv, Wo, seg_len):
        B, S, Dm = x.shape
        H, Dh = (Wq.shape[1], Wq.shape[2])
        M = mem0.shape[1]
        scale = Dh ** (-0.5)
        n_seg = S // seg_len
        L = M + seg_len
        idx = torch.arange(L)
        mask = (idx[:, None] < M) | (idx[:, None] >= idx[None, :])
        mem = mem0
        outs = []
        for s in range(n_seg):
            xs = x[:, s * seg_len:(s + 1) * seg_len, :].clone()
            h = torch.concatenate([mem, xs], axis=1)
            q = torch.einsum('btd,dhe->bhte', h, Wq)
            k = torch.einsum('btd,dhe->bhte', h, Wk)
            v = torch.einsum('btd,dhe->bhte', h, Wv)
            scores = torch.einsum('bhqe,bhke->bhqk', q, k) * scale
            scores = torch.where(mask[None, None], scores, -1000000000.0)
            p = _softmax(scores, axis=-1)
            o = torch.einsum('bhqk,bhke->bhqe', p, v)
            o = torch.einsum('bhte,hed->btd', o, Wo)
            mem = o[:, :M, :].clone()
            outs.append(o[:, M:, :])
        return torch.concatenate(outs, axis=1)

    def _B_ref(q, k, v, shift_k, ssm_k, ssm_D):
        B, S, D = q.shape
        ks = shift_k.shape[-1]
        k_pad = _pad(k, ((0, 0), (ks - 1, 0), (0, 0)))
        k_shift = torch.zeros_like(k)
        for t in range(ks):
            k_shift = k_shift + k_pad[:, t:t + S, :] * shift_k[:, ks - 1 - t][None, None, :]
        kv = k_shift * v
        L = 2 * S
        kv_pad = _pad(kv, ((0, 0), (0, S), (0, 0)))
        kf_pad = _pad(ssm_k, ((0, 0), (0, S)))
        kv_f = (lambda x, axes=(-2, -1): torch.fft.rfft2(x.float(), dim=axes))(kv_pad[:, None, :, :], axes=(1, 2))
        kf_f = (lambda x, axes=(-2, -1): torch.fft.rfft2(x.float(), dim=axes))(kf_pad[:, None, :], axes=(1, 2))
        kf_f = (lambda x, *d: x.permute(*d))(kf_f, 1, 2, 0)
        y_f = kv_f * kf_f[None, :, :, :]
        y = (lambda x, s, axes=(-2, -1): torch.fft.irfft2(x, s=s, dim=axes).to(torch.bfloat16))(y_f, (1, L), axes=(1, 2))[:, 0, :S, :]
        y = y + kv * ssm_D[None, None, :]
        return q * y
    a = _A_ref(A_x, A_mem0, A_Wq, A_Wk, A_Wv, A_Wo, A_seg_len)
    b = _B_ref(B_q, B_k, B_v, B_shift_k, B_ssm_k, B_ssm_D)
    return torch.concatenate([a, b], axis=-1)
```

```asm
; @launch grid=(256,1,1) block=(256,1,1) lds=163840
.amdgcn_target "amdgcn-amd-amdhsa--gfx950"
.text
.globl concat_heads__memory_aug_recurrent_mem_tr__ssm_conv_h3__prompt_kernel
.p2align 8
.type concat_heads__memory_aug_recurrent_mem_tr__ssm_conv_h3__prompt_kernel,@function
concat_heads__memory_aug_recurrent_mem_tr__ssm_conv_h3__prompt_kernel:
    s_load_dwordx16 s[64:79], s[0:1], 0
    s_load_dwordx16 s[80:95], s[0:1], 64
    s_memrealtime s[30:31]
    v_lshrrev_b32 v1, 6, v0
    v_and_b32 v0, 63, v0
    s_getreg_b32 s26, hwreg(HW_REG_XCC_ID)
    v_readfirstlane_b32 s20, v1
    s_and_b32 s26, s26, 7
    s_mov_b32 s21, s26
    s_lshr_b32 s22, s2, 3
    s_lshl_b32 s27, s20, 10
    s_mov_b32 s101, 1
    s_waitcnt lgkmcnt(0)
    s_or_b32 s23, s30, 1
    s_mov_b32 s4, s94
    s_and_b32 s5, s95, 0xffff
    s_mov_b32 s6, 0x10000000
    s_mov_b32 s7, 0x00020000
    s_mov_b32 s8, s92
    s_and_b32 s9, s93, 0xffff
    s_mov_b32 s10, 0x100
    s_mov_b32 s11, 0x00020000
    s_cmp_lt_u32 s22, 32
    s_cbranch_scc1 L_disp
L_slow:
    s_waitcnt vmcnt(0) lgkmcnt(0)
    s_barrier
    v_mbcnt_lo_u32_b32 v0, -1, 0
    v_mbcnt_hi_u32_b32 v0, -1, v0
    s_mov_b32 s101, 0
    s_cmp_lg_u32 s20, 0
    s_cbranch_scc1 L_claimed
    s_mov_b64 exec, 1
    v_mov_b32 v2, s23
    v_mov_b32 v3, 0
    v_mov_b32 v4, 32
    buffer_atomic_cmpswap v[2:3], v4, s[8:11], 0 offen sc0 sc1
    s_mov_b32 s21, s26
    s_mov_b32 s29, 0
    s_mov_b32 s31, 0
L_claim:
    s_add_u32 s31, s31, 1
    s_cmp_gt_u32 s31, 400
    s_cbranch_scc1 L_none
    v_mov_b32 v5, 0
    s_lshl_b32 s28, s21, 2
    s_cselect_b32 s30, 128, 0
    s_add_u32 s28, s28, s30
    v_mov_b32 v6, s28
    buffer_atomic_or v5, v6, s[8:11], 0 offen sc0 sc1
    s_waitcnt vmcnt(0)
    v_readfirstlane_b32 s28, v5
    s_ff0_i32_b32 s22, s28
    s_cmp_lt_i32 s22, 0
    s_cbranch_scc1 L_next
    s_lshl_b32 s28, 1, s22
    v_mov_b32 v5, s28
    buffer_atomic_or v5, v6, s[8:11], 0 offen sc0 sc1
    s_waitcnt vmcnt(0)
    v_readfirstlane_b32 s28, v5
    s_bitcmp1_b32 s28, s22
    s_cbranch_scc1 L_claim
    s_branch L_got
L_next:
    s_add_u32 s21, s21, 1
    s_and_b32 s21, s21, 7
    s_add_u32 s29, s29, 1
    s_cmp_lt_u32 s29, 8
    s_cbranch_scc1 L_claim
L_none:
    s_mov_b32 s21, 8
L_got:
    v_readfirstlane_b32 s28, v2
    s_cmp_eq_u32 s28, 0
    s_cselect_b32 s23, s23, s28
    v_mov_b32 v4, s21
    v_mov_b32 v5, s22
    v_mov_b32 v6, s23
    v_mov_b32 v7, 0
    v_mov_b32 v8, 0x27ff0
    ds_write_b128 v8, v[4:7]
    s_waitcnt lgkmcnt(0)
    s_mov_b64 exec, -1
L_claimed:
    s_barrier
    v_mov_b32 v8, 0x27ff0
    ds_read_b128 v[4:7], v8
    s_waitcnt lgkmcnt(0)
    v_readfirstlane_b32 s21, v4
    v_readfirstlane_b32 s22, v5
    v_readfirstlane_b32 s23, v6
    s_barrier
    s_cmp_gt_u32 s21, 7
    s_cbranch_scc1 L_end
L_disp:
    s_cmp_eq_u32 s20, 0
    s_cselect_b32 s3, s101, 0
    s_cmp_eq_u32 s21, 0
    s_cbranch_scc1 L_head
    s_sub_u32 s28, s21, 1
    s_lshl_b32 s28, s28, 5
    s_add_u32 s28, s28, s22
    s_mul_i32 s24, s28, 9363
    s_lshr_b32 s24, s24, 16
    s_mul_i32 s29, s24, 7
    s_sub_u32 s25, s28, s29
    s_mov_b32 s32, s28
    v_lshrrev_b32 v3, 4, v0
    s_lshr_b32 s28, s20, 1
    s_lshl_b32 s28, s28, 2
    v_or_b32 v4, s28, v3
    v_lshlrev_b32 v4, 1, v4
    v_and_b32 v5, 15, v0
    v_xor_b32 v4, v4, v5
    v_lshlrev_b32 v4, 4, v4
    s_lshl_b32 s28, s20, 2
    v_add_u32 v5, s28, v3
    v_lshlrev_b32 v5, 13, v5
    s_lshl_b32 s28, s24, 8
    v_add3_u32 v2, v4, v5, s28
    v_bfe_u32 v4, v0, 2, 2
    v_lshlrev_b32 v5, 3, v3
    v_add_u32 v5, v5, v4
    v_lshlrev_b32 v5, 8, v5
    v_and_b32 v8, 1, v3
    v_lshlrev_b32 v8, 2, v8
    v_or_b32 v4, v4, v8
    s_lshl_b32 s28, s20, 1
    v_xor_b32 v4, s28, v4
    v_lshlrev_b32 v4, 5, v4
    v_and_b32 v8, 3, v0
    v_lshlrev_b32 v8, 3, v8
    v_add3_u32 v6, v5, v4, v8
    v_xor_b32 v7, 32, v6
    v_add_u32 v8, 0x10000, v6
    v_add_u32 v9, 0x10000, v7
    s_cmp_eq_u32 s3, 0
    s_cbranch_scc1 L_lw_1
    s_lshl_b32 s28, 1, s22
    v_mov_b32 v56, s23
    v_mov_b32 v57, 0
    v_mov_b32 v58, s28
    s_lshl_b32 s28, s21, 2
    v_mov_b32 v59, s28
    v_mov_b32 v60, 32
    s_mov_b64 exec, 1

    buffer_atomic_or v58, v59, s[8:11], 0 offen offset:128 sc0 sc1
    s_mov_b64 exec, -1
L_lw_1:
    s_mov_b32 s12, s70
    s_and_b32 s13, s71, 0xffff
    s_mov_b32 s14, 0x400000
    s_mov_b32 s15, 0x00020000
    s_add_u32 m0, s27, 0x0
    s_mov_b32 s28, 0x0
    buffer_load_dwordx4 v2, s[12:15], s28 offen lds
    s_add_u32 m0, s27, 0x1000
    s_mov_b32 s28, 0x20000
    buffer_load_dwordx4 v2, s[12:15], s28 offen lds
    s_add_u32 m0, s27, 0x2000
    s_mov_b32 s28, 0x40000
    buffer_load_dwordx4 v2, s[12:15], s28 offen lds
    s_add_u32 m0, s27, 0x3000
    s_mov_b32 s28, 0x60000
    buffer_load_dwordx4 v2, s[12:15], s28 offen lds
    s_add_u32 m0, s27, 0x4000
    s_mov_b32 s28, 0x80000
    buffer_load_dwordx4 v2, s[12:15], s28 offen lds
    s_add_u32 m0, s27, 0x5000
    s_mov_b32 s28, 0xa0000
    buffer_load_dwordx4 v2, s[12:15], s28 offen lds
    s_add_u32 m0, s27, 0x6000
    s_mov_b32 s28, 0xc0000
    buffer_load_dwordx4 v2, s[12:15], s28 offen lds
    s_add_u32 m0, s27, 0x7000
    s_mov_b32 s28, 0xe0000
    buffer_load_dwordx4 v2, s[12:15], s28 offen lds
    s_add_u32 m0, s27, 0x8000
    s_mov_b32 s28, 0x100000
    buffer_load_dwordx4 v2, s[12:15], s28 offen lds
    s_add_u32 m0, s27, 0x9000
    s_mov_b32 s28, 0x120000
    buffer_load_dwordx4 v2, s[12:15], s28 offen lds
    s_add_u32 m0, s27, 0xa000
    s_mov_b32 s28, 0x140000
    buffer_load_dwordx4 v2, s[12:15], s28 offen lds
    s_add_u32 m0, s27, 0xb000
    s_mov_b32 s28, 0x160000
    buffer_load_dwordx4 v2, s[12:15], s28 offen lds
    s_add_u32 m0, s27, 0xc000
    s_mov_b32 s28, 0x180000
    buffer_load_dwordx4 v2, s[12:15], s28 offen lds
    s_add_u32 m0, s27, 0xd000
    s_mov_b32 s28, 0x1a0000
    buffer_load_dwordx4 v2, s[12:15], s28 offen lds
    s_add_u32 m0, s27, 0xe000
    s_mov_b32 s28, 0x1c0000
    buffer_load_dwordx4 v2, s[12:15], s28 offen lds
    s_add_u32 m0, s27, 0xf000
    s_mov_b32 s28, 0x1e0000
    buffer_load_dwordx4 v2, s[12:15], s28 offen lds
    s_add_u32 m0, s27, 0x10000
    s_mov_b32 s28, 0x200000
    buffer_load_dwordx4 v2, s[12:15], s28 offen lds
    s_add_u32 m0, s27, 0x11000
    s_mov_b32 s28, 0x220000
    buffer_load_dwordx4 v2, s[12:15], s28 offen lds
    s_add_u32 m0, s27, 0x12000
    s_mov_b32 s28, 0x240000
    buffer_load_dwordx4 v2, s[12:15], s28 offen lds
    s_add_u32 m0, s27, 0x13000
    s_mov_b32 s28, 0x260000
    buffer_load_dwordx4 v2, s[12:15], s28 offen lds
    s_add_u32 m0, s27, 0x14000
    s_mov_b32 s28, 0x280000
    buffer_load_dwordx4 v2, s[12:15], s28 offen lds
    s_add_u32 m0, s27, 0x15000
    s_mov_b32 s28, 0x2a0000
    buffer_load_dwordx4 v2, s[12:15], s28 offen lds
    s_add_u32 m0, s27, 0x16000
    s_mov_b32 s28, 0x2c0000
    buffer_load_dwordx4 v2, s[12:15], s28 offen lds
    s_add_u32 m0, s27, 0x17000
    s_mov_b32 s28, 0x2e0000
    buffer_load_dwordx4 v2, s[12:15], s28 offen lds
    s_add_u32 m0, s27, 0x18000
    s_mov_b32 s28, 0x300000
    buffer_load_dwordx4 v2, s[12:15], s28 offen lds
    s_add_u32 m0, s27, 0x19000
    s_mov_b32 s28, 0x320000
    buffer_load_dwordx4 v2, s[12:15], s28 offen lds
    s_add_u32 m0, s27, 0x1a000
    s_mov_b32 s28, 0x340000
    buffer_load_dwordx4 v2, s[12:15], s28 offen lds
    s_add_u32 m0, s27, 0x1b000
    s_mov_b32 s28, 0x360000
    buffer_load_dwordx4 v2, s[12:15], s28 offen lds
    s_add_u32 m0, s27, 0x1c000
    s_mov_b32 s28, 0x380000
    buffer_load_dwordx4 v2, s[12:15], s28 offen lds
    s_add_u32 m0, s27, 0x1d000
    s_mov_b32 s28, 0x3a0000
    buffer_load_dwordx4 v2, s[12:15], s28 offen lds
    s_add_u32 m0, s27, 0x1e000
    s_mov_b32 s28, 0x3c0000
    buffer_load_dwordx4 v2, s[12:15], s28 offen lds
    s_add_u32 m0, s27, 0x1f000
    s_mov_b32 s28, 0x3e0000
    buffer_load_dwordx4 v2, s[12:15], s28 offen lds
    s_waitcnt vmcnt(16)
    s_barrier
    ds_read_b64_tr_b16 a[0:1], v6 offset:0
    ds_read_b64_tr_b16 a[2:3], v6 offset:1024
    ds_read_b64_tr_b16 a[64:65], v7 offset:0
    ds_read_b64_tr_b16 a[66:67], v7 offset:1024
    ds_read_b64_tr_b16 a[4:5], v6 offset:8192
    ds_read_b64_tr_b16 a[6:7], v6 offset:9216
    ds_read_b64_tr_b16 a[68:69], v7 offset:8192
    ds_read_b64_tr_b16 a[70:71], v7 offset:9216
    ds_read_b64_tr_b16 a[8:9], v6 offset:16384
    ds_read_b64_tr_b16 a[10:11], v6 offset:17408
    ds_read_b64_tr_b16 a[72:73], v7 offset:16384
    ds_read_b64_tr_b16 a[74:75], v7 offset:17408
    ds_read_b64_tr_b16 a[12:13], v6 offset:24576
    ds_read_b64_tr_b16 a[14:15], v6 offset:25600
    ds_read_b64_tr_b16 a[76:77], v7 offset:24576
    ds_read_b64_tr_b16 a[78:79], v7 offset:25600
    ds_read_b64_tr_b16 a[16:17], v6 offset:32768
    ds_read_b64_tr_b16 a[18:19], v6 offset:33792
    ds_read_b64_tr_b16 a[80:81], v7 offset:32768
    ds_read_b64_tr_b16 a[82:83], v7 offset:33792
    ds_read_b64_tr_b16 a[20:21], v6 offset:40960
    ds_read_b64_tr_b16 a[22:23], v6 offset:41984
    ds_read_b64_tr_b16 a[84:85], v7 offset:40960
    ds_read_b64_tr_b16 a[86:87], v7 offset:41984
    ds_read_b64_tr_b16 a[24:25], v6 offset:49152
    ds_read_b64_tr_b16 a[26:27], v6 offset:50176
    ds_read_b64_tr_b16 a[88:89], v7 offset:49152
    ds_read_b64_tr_b16 a[90:91], v7 offset:50176
    ds_read_b64_tr_b16 a[28:29], v6 offset:57344
    ds_read_b64_tr_b16 a[30:31], v6 offset:58368
    ds_read_b64_tr_b16 a[92:93], v7 offset:57344
    ds_read_b64_tr_b16 a[94:95], v7 offset:58368
    s_waitcnt lgkmcnt(0)
    s_barrier
    s_mov_b32 s40, s64
    s_and_b32 s41, s65, 0xffff
    s_mov_b32 s42, 0x200000
    s_mov_b32 s43, 0x00020000
    v_and_b32 v4, 15, v0
    v_lshlrev_b32 v4, 10, v4
    v_lshl_add_u32 v10, v3, 4, v4
    s_lshl_b32 s28, s20, 8
    v_add_u32 v10, s28, v10
    v_add_u32 v11, 0x4000, v10
    v_lshlrev_b32 v14, 4, v0
    v_add_u32 v12, s27, v14
    v_add_u32 v13, s27, v12
    v_add_u32 v14, 0x20000, v14
    s_mov_b32 s33, s25
    s_lshl_b32 s34, s33, 15
    s_lshl_b32 s44, s20, 13
    s_add_u32 s44, s44, 0x20000
    s_add_u32 m0, s44, 0
    s_nop 0
    buffer_load_dwordx4 v10, s[40:43], s34 offen offset:0 lds
    s_add_u32 m0, s44, 1024
    s_nop 0
    buffer_load_dwordx4 v11, s[40:43], s34 offen offset:0 lds
    s_add_u32 m0, s44, 1984
    s_nop 0
    buffer_load_dwordx4 v10, s[40:43], s34 offen offset:64 lds
    s_add_u32 m0, s44, 3008
    s_nop 0
    buffer_load_dwordx4 v11, s[40:43], s34 offen offset:64 lds
    s_add_u32 m0, s44, 3968
    s_nop 0
    buffer_load_dwordx4 v10, s[40:43], s34 offen offset:128 lds
    s_add_u32 m0, s44, 4992
    s_nop 0
    buffer_load_dwordx4 v11, s[40:43], s34 offen offset:128 lds
    s_add_u32 m0, s44, 5952
    s_nop 0
    buffer_load_dwordx4 v10, s[40:43], s34 offen offset:192 lds
    s_add_u32 m0, s44, 6976
    s_nop 0
    buffer_load_dwordx4 v11, s[40:43], s34 offen offset:192 lds
    s_mov_b32 s16, s72
    s_and_b32 s17, s73, 0xffff
    s_mov_b32 s18, 0x400000
    s_mov_b32 s19, 0x00020000
    s_add_u32 m0, s27, 0x0
    s_mov_b32 s28, 0x0
    buffer_load_dwordx4 v2, s[16:19], s28 offen lds
    s_add_u32 m0, s27, 0x1000
    s_mov_b32 s28, 0x20000
    buffer_load_dwordx4 v2, s[16:19], s28 offen lds
    s_add_u32 m0, s27, 0x2000
    s_mov_b32 s28, 0x40000
    buffer_load_dwordx4 v2, s[16:19], s28 offen lds
    s_add_u32 m0, s27, 0x3000
    s_mov_b32 s28, 0x60000
    buffer_load_dwordx4 v2, s[16:19], s28 offen lds
    s_add_u32 m0, s27, 0x4000
    s_mov_b32 s28, 0x80000
    buffer_load_dwordx4 v2, s[16:19], s28 offen lds
    s_add_u32 m0, s27, 0x5000
    s_mov_b32 s28, 0xa0000
    buffer_load_dwordx4 v2, s[16:19], s28 offen lds
    s_add_u32 m0, s27, 0x6000
    s_mov_b32 s28, 0xc0000
    buffer_load_dwordx4 v2, s[16:19], s28 offen lds
    s_add_u32 m0, s27, 0x7000
    s_mov_b32 s28, 0xe0000
    buffer_load_dwordx4 v2, s[16:19], s28 offen lds
    s_add_u32 m0, s27, 0x8000
    s_mov_b32 s28, 0x100000
    buffer_load_dwordx4 v2, s[16:19], s28 offen lds
    s_add_u32 m0, s27, 0x9000
    s_mov_b32 s28, 0x120000
    buffer_load_dwordx4 v2, s[16:19], s28 offen lds
    s_add_u32 m0, s27, 0xa000
    s_mov_b32 s28, 0x140000
    buffer_load_dwordx4 v2, s[16:19], s28 offen lds
    s_add_u32 m0, s27, 0xb000
    s_mov_b32 s28, 0x160000
    buffer_load_dwordx4 v2, s[16:19], s28 offen lds
    s_add_u32 m0, s27, 0xc000
    s_mov_b32 s28, 0x180000
    buffer_load_dwordx4 v2, s[16:19], s28 offen lds
    s_add_u32 m0, s27, 0xd000
    s_mov_b32 s28, 0x1a0000
    buffer_load_dwordx4 v2, s[16:19], s28 offen lds
    s_add_u32 m0, s27, 0xe000
    s_mov_b32 s28, 0x1c0000
    buffer_load_dwordx4 v2, s[16:19], s28 offen lds
    s_add_u32 m0, s27, 0xf000
    s_mov_b32 s28, 0x1e0000
    buffer_load_dwordx4 v2, s[16:19], s28 offen lds
    s_waitcnt vmcnt(24)
    s_barrier
    ds_read_b64_tr_b16 a[32:33], v8 offset:0
    ds_read_b64_tr_b16 a[34:35], v8 offset:1024
    ds_read_b64_tr_b16 a[96:97], v9 offset:0
    ds_read_b64_tr_b16 a[98:99], v9 offset:1024
    ds_read_b64_tr_b16 a[36:37], v8 offset:8192
    ds_read_b64_tr_b16 a[38:39], v8 offset:9216
    ds_read_b64_tr_b16 a[100:101], v9 offset:8192
    ds_read_b64_tr_b16 a[102:103], v9 offset:9216
    ds_read_b64_tr_b16 a[40:41], v8 offset:16384
    ds_read_b64_tr_b16 a[42:43], v8 offset:17408
    ds_read_b64_tr_b16 a[104:105], v9 offset:16384
    ds_read_b64_tr_b16 a[106:107], v9 offset:17408
    ds_read_b64_tr_b16 a[44:45], v8 offset:24576
    ds_read_b64_tr_b16 a[46:47], v8 offset:25600
    ds_read_b64_tr_b16 a[108:109], v9 offset:24576
    ds_read_b64_tr_b16 a[110:111], v9 offset:25600
    ds_read_b64_tr_b16 a[48:49], v8 offset:32768
    ds_read_b64_tr_b16 a[50:51], v8 offset:33792
    ds_read_b64_tr_b16 a[112:113], v9 offset:32768
    ds_read_b64_tr_b16 a[114:115], v9 offset:33792
    ds_read_b64_tr_b16 a[52:53], v8 offset:40960
    ds_read_b64_tr_b16 a[54:55], v8 offset:41984
    ds_read_b64_tr_b16 a[116:117], v9 offset:40960
    ds_read_b64_tr_b16 a[118:119], v9 offset:41984
    ds_read_b64_tr_b16 a[56:57], v8 offset:49152
    ds_read_b64_tr_b16 a[58:59], v8 offset:50176
    ds_read_b64_tr_b16 a[120:121], v9 offset:49152
    ds_read_b64_tr_b16 a[122:123], v9 offset:50176
    ds_read_b64_tr_b16 a[60:61], v8 offset:57344
    ds_read_b64_tr_b16 a[62:63], v8 offset:58368
    ds_read_b64_tr_b16 a[124:125], v9 offset:57344
    ds_read_b64_tr_b16 a[126:127], v9 offset:58368
    s_waitcnt lgkmcnt(0)
    s_barrier
    s_add_u32 m0, s27, 0x10000
    s_mov_b32 s28, 0x200000
    buffer_load_dwordx4 v2, s[16:19], s28 offen lds
    s_add_u32 m0, s27, 0x11000
    s_mov_b32 s28, 0x220000
    buffer_load_dwordx4 v2, s[16:19], s28 offen lds
    s_add_u32 m0, s27, 0x12000
    s_mov_b32 s28, 0x240000
    buffer_load_dwordx4 v2, s[16:19], s28 offen lds
    s_add_u32 m0, s27, 0x13000
    s_mov_b32 s28, 0x260000
    buffer_load_dwordx4 v2, s[16:19], s28 offen lds
    s_add_u32 m0, s27, 0x14000
    s_mov_b32 s28, 0x280000
    buffer_load_dwordx4 v2, s[16:19], s28 offen lds
    s_add_u32 m0, s27, 0x15000
    s_mov_b32 s28, 0x2a0000
    buffer_load_dwordx4 v2, s[16:19], s28 offen lds
    s_add_u32 m0, s27, 0x16000
    s_mov_b32 s28, 0x2c0000
    buffer_load_dwordx4 v2, s[16:19], s28 offen lds
    s_add_u32 m0, s27, 0x17000
    s_mov_b32 s28, 0x2e0000
    buffer_load_dwordx4 v2, s[16:19], s28 offen lds
    s_add_u32 m0, s27, 0x18000
    s_mov_b32 s28, 0x300000
    buffer_load_dwordx4 v2, s[16:19], s28 offen lds
    s_add_u32 m0, s27, 0x19000
    s_mov_b32 s28, 0x320000
    buffer_load_dwordx4 v2, s[16:19], s28 offen lds
    s_add_u32 m0, s27, 0x1a000
    s_mov_b32 s28, 0x340000
    buffer_load_dwordx4 v2, s[16:19], s28 offen lds
    s_add_u32 m0, s27, 0x1b000
    s_mov_b32 s28, 0x360000
    buffer_load_dwordx4 v2, s[16:19], s28 offen lds
    s_add_u32 m0, s27, 0x1c000
    s_mov_b32 s28, 0x380000
    buffer_load_dwordx4 v2, s[16:19], s28 offen lds
    s_add_u32 m0, s27, 0x1d000
    s_mov_b32 s28, 0x3a0000
    buffer_load_dwordx4 v2, s[16:19], s28 offen lds
    s_add_u32 m0, s27, 0x1e000
    s_mov_b32 s28, 0x3c0000
    buffer_load_dwordx4 v2, s[16:19], s28 offen lds
    s_add_u32 m0, s27, 0x1f000
    s_mov_b32 s28, 0x3e0000
    buffer_load_dwordx4 v2, s[16:19], s28 offen lds
    s_waitcnt vmcnt(16)
    s_barrier
    ds_read_b64_tr_b16 a[128:129], v6 offset:0
    ds_read_b64_tr_b16 a[130:131], v6 offset:1024
    ds_read_b64_tr_b16 a[192:193], v7 offset:0
    ds_read_b64_tr_b16 a[194:195], v7 offset:1024
    ds_read_b64_tr_b16 a[132:133], v6 offset:8192
    ds_read_b64_tr_b16 a[134:135], v6 offset:9216
    ds_read_b64_tr_b16 a[196:197], v7 offset:8192
    ds_read_b64_tr_b16 a[198:199], v7 offset:9216
    ds_read_b64_tr_b16 a[136:137], v6 offset:16384
    ds_read_b64_tr_b16 a[138:139], v6 offset:17408
    ds_read_b64_tr_b16 a[200:201], v7 offset:16384
    ds_read_b64_tr_b16 a[202:203], v7 offset:17408
    ds_read_b64_tr_b16 a[140:141], v6 offset:24576
    ds_read_b64_tr_b16 a[142:143], v6 offset:25600
    ds_read_b64_tr_b16 a[204:205], v7 offset:24576
    ds_read_b64_tr_b16 a[206:207], v7 offset:25600
    ds_read_b64_tr_b16 a[144:145], v6 offset:32768
    ds_read_b64_tr_b16 a[146:147], v6 offset:33792
    ds_read_b64_tr_b16 a[208:209], v7 offset:32768
    ds_read_b64_tr_b16 a[210:211], v7 offset:33792
    ds_read_b64_tr_b16 a[148:149], v6 offset:40960
    ds_read_b64_tr_b16 a[150:151], v6 offset:41984
    ds_read_b64_tr_b16 a[212:213], v7 offset:40960
    ds_read_b64_tr_b16 a[214:215], v7 offset:41984
    ds_read_b64_tr_b16 a[152:153], v6 offset:49152
    ds_read_b64_tr_b16 a[154:155], v6 offset:50176
    ds_read_b64_tr_b16 a[216:217], v7 offset:49152
    ds_read_b64_tr_b16 a[218:219], v7 offset:50176
    ds_read_b64_tr_b16 a[156:157], v6 offset:57344
    ds_read_b64_tr_b16 a[158:159], v6 offset:58368
    ds_read_b64_tr_b16 a[220:221], v7 offset:57344
    ds_read_b64_tr_b16 a[222:223], v7 offset:58368
    s_waitcnt lgkmcnt(0)
    s_barrier
    s_mov_b32 s12, s68
    s_and_b32 s13, s69, 0xffff
    s_mov_b32 s14, 0x400000
    s_mov_b32 s15, 0x00020000
    s_add_u32 m0, s27, 0x0
    s_mov_b32 s28, 0x0
    buffer_load_dwordx4 v2, s[12:15], s28 offen lds
    s_add_u32 m0, s27, 0x1000
    s_mov_b32 s28, 0x20000
    buffer_load_dwordx4 v2, s[12:15], s28 offen lds
    s_add_u32 m0, s27, 0x2000
    s_mov_b32 s28, 0x40000
    buffer_load_dwordx4 v2, s[12:15], s28 offen lds
    s_add_u32 m0, s27, 0x3000
    s_mov_b32 s28, 0x60000
    buffer_load_dwordx4 v2, s[12:15], s28 offen lds
    s_add_u32 m0, s27, 0x4000
    s_mov_b32 s28, 0x80000
    buffer_load_dwordx4 v2, s[12:15], s28 offen lds
    s_add_u32 m0, s27, 0x5000
    s_mov_b32 s28, 0xa0000
    buffer_load_dwordx4 v2, s[12:15], s28 offen lds
    s_add_u32 m0, s27, 0x6000
    s_mov_b32 s28, 0xc0000
    buffer_load_dwordx4 v2, s[12:15], s28 offen lds
    s_add_u32 m0, s27, 0x7000
    s_mov_b32 s28, 0xe0000
    buffer_load_dwordx4 v2, s[12:15], s28 offen lds
    s_add_u32 m0, s27, 0x8000
    s_mov_b32 s28, 0x100000
    buffer_load_dwordx4 v2, s[12:15], s28 offen lds
    s_add_u32 m0, s27, 0x9000
    s_mov_b32 s28, 0x120000
    buffer_load_dwordx4 v2, s[12:15], s28 offen lds
    s_add_u32 m0, s27, 0xa000
    s_mov_b32 s28, 0x140000
    buffer_load_dwordx4 v2, s[12:15], s28 offen lds
    s_add_u32 m0, s27, 0xb000
    s_mov_b32 s28, 0x160000
    buffer_load_dwordx4 v2, s[12:15], s28 offen lds
    s_add_u32 m0, s27, 0xc000
    s_mov_b32 s28, 0x180000
    buffer_load_dwordx4 v2, s[12:15], s28 offen lds
    s_add_u32 m0, s27, 0xd000
    s_mov_b32 s28, 0x1a0000
    buffer_load_dwordx4 v2, s[12:15], s28 offen lds
    s_add_u32 m0, s27, 0xe000
    s_mov_b32 s28, 0x1c0000
    buffer_load_dwordx4 v2, s[12:15], s28 offen lds
    s_add_u32 m0, s27, 0xf000
    s_mov_b32 s28, 0x1e0000
    buffer_load_dwordx4 v2, s[12:15], s28 offen lds
    s_cmp_eq_u32 s3, 0
    s_cbranch_scc1 L_lw_2a
    v_mov_b32 v60, 32
    s_mov_b64 exec, 1
    buffer_load_dword v61, v60, s[8:11], 0 offen sc0 sc1
    s_mov_b64 exec, -1
    s_waitcnt vmcnt(17)
    s_branch L_lw_2b
L_lw_2a:
    s_waitcnt vmcnt(16)
L_lw_2b:
    s_barrier
    ds_read_b64_tr_b16 a[160:161], v8 offset:0
    ds_read_b64_tr_b16 a[162:163], v8 offset:1024
    ds_read_b64_tr_b16 a[224:225], v9 offset:0
    ds_read_b64_tr_b16 a[226:227], v9 offset:1024
    ds_read_b64_tr_b16 a[164:165], v8 offset:8192
    ds_read_b64_tr_b16 a[166:167], v8 offset:9216
    ds_read_b64_tr_b16 a[228:229], v9 offset:8192
    ds_read_b64_tr_b16 a[230:231], v9 offset:9216
    ds_read_b64_tr_b16 a[168:169], v8 offset:16384
    ds_read_b64_tr_b16 a[170:171], v8 offset:17408
    ds_read_b64_tr_b16 a[232:233], v9 offset:16384
    ds_read_b64_tr_b16 a[234:235], v9 offset:17408
    ds_read_b64_tr_b16 a[172:173], v8 offset:24576
    ds_read_b64_tr_b16 a[174:175], v8 offset:25600
    ds_read_b64_tr_b16 a[236:237], v9 offset:24576
    ds_read_b64_tr_b16 a[238:239], v9 offset:25600
    ds_read_b64_tr_b16 a[176:177], v8 offset:32768
    ds_read_b64_tr_b16 a[178:179], v8 offset:33792
    ds_read_b64_tr_b16 a[240:241], v9 offset:32768
    ds_read_b64_tr_b16 a[242:243], v9 offset:33792
    ds_read_b64_tr_b16 a[180:181], v8 offset:40960
    ds_read_b64_tr_b16 a[182:183], v8 offset:41984
    ds_read_b64_tr_b16 a[244:245], v9 offset:40960
    ds_read_b64_tr_b16 a[246:247], v9 offset:41984
    ds_read_b64_tr_b16 a[184:185], v8 offset:49152
    ds_read_b64_tr_b16 a[186:187], v8 offset:50176
    ds_read_b64_tr_b16 a[248:249], v9 offset:49152
    ds_read_b64_tr_b16 a[250:251], v9 offset:50176
    ds_read_b64_tr_b16 a[188:189], v8 offset:57344
    ds_read_b64_tr_b16 a[190:191], v8 offset:58368
    ds_read_b64_tr_b16 a[252:253], v9 offset:57344
    ds_read_b64_tr_b16 a[254:255], v9 offset:58368
    s_waitcnt lgkmcnt(0)
    s_barrier
    s_add_u32 m0, s27, 0x10000
    s_mov_b32 s28, 0x200000
    buffer_load_dwordx4 v2, s[12:15], s28 offen lds
    s_add_u32 m0, s27, 0x11000
    s_mov_b32 s28, 0x220000
    buffer_load_dwordx4 v2, s[12:15], s28 offen lds
    s_add_u32 m0, s27, 0x12000
    s_mov_b32 s28, 0x240000
    buffer_load_dwordx4 v2, s[12:15], s28 offen lds
    s_add_u32 m0, s27, 0x13000
    s_mov_b32 s28, 0x260000
    buffer_load_dwordx4 v2, s[12:15], s28 offen lds
    s_add_u32 m0, s27, 0x14000
    s_mov_b32 s28, 0x280000
    buffer_load_dwordx4 v2, s[12:15], s28 offen lds
    s_add_u32 m0, s27, 0x15000
    s_mov_b32 s28, 0x2a0000
    buffer_load_dwordx4 v2, s[12:15], s28 offen lds
    s_add_u32 m0, s27, 0x16000
    s_mov_b32 s28, 0x2c0000
    buffer_load_dwordx4 v2, s[12:15], s28 offen lds
    s_add_u32 m0, s27, 0x17000
    s_mov_b32 s28, 0x2e0000
    buffer_load_dwordx4 v2, s[12:15], s28 offen lds
    s_add_u32 m0, s27, 0x18000
    s_mov_b32 s28, 0x300000
    buffer_load_dwordx4 v2, s[12:15], s28 offen lds
    s_add_u32 m0, s27, 0x19000
    s_mov_b32 s28, 0x320000
    buffer_load_dwordx4 v2, s[12:15], s28 offen lds
    s_add_u32 m0, s27, 0x1a000
    s_mov_b32 s28, 0x340000
    buffer_load_dwordx4 v2, s[12:15], s28 offen lds
    s_add_u32 m0, s27, 0x1b000
    s_mov_b32 s28, 0x360000
    buffer_load_dwordx4 v2, s[12:15], s28 offen lds
    s_add_u32 m0, s27, 0x1c000
    s_mov_b32 s28, 0x380000
    buffer_load_dwordx4 v2, s[12:15], s28 offen lds
    s_add_u32 m0, s27, 0x1d000
    s_mov_b32 s28, 0x3a0000
    buffer_load_dwordx4 v2, s[12:15], s28 offen lds
    s_add_u32 m0, s27, 0x1e000
    s_mov_b32 s28, 0x3c0000
    buffer_load_dwordx4 v2, s[12:15], s28 offen lds
    s_add_u32 m0, s27, 0x1f000
    s_mov_b32 s28, 0x3e0000
    buffer_load_dwordx4 v2, s[12:15], s28 offen lds
    s_cmp_eq_u32 s3, 0
    s_cbranch_scc1 L_lw_3a
    s_waitcnt vmcnt(17)
    s_branch L_lw_3b
L_lw_3a:
    s_waitcnt vmcnt(16)
L_lw_3b:
    s_barrier
    ds_read_b128 v[64:67], v14 offset:0
    ds_read_b128 v[68:71], v14 offset:1024
    ds_read_b128 v[72:75], v14 offset:2048
    ds_read_b128 v[76:79], v14 offset:3072
    ds_read_b128 v[80:83], v14 offset:4096
    ds_read_b128 v[84:87], v14 offset:5120
    ds_read_b128 v[88:91], v14 offset:6144
    ds_read_b128 v[92:95], v14 offset:7168
    s_waitcnt lgkmcnt(6)
    v_mfma_f32_16x16x32_bf16 v[16:19], a[0:3], v[64:67], 0
    v_mfma_f32_16x16x32_bf16 v[20:23], a[0:3], v[68:71], 0
    v_mfma_f32_16x16x32_bf16 v[24:27], a[64:67], v[64:67], 0
    v_mfma_f32_16x16x32_bf16 v[28:31], a[64:67], v[68:71], 0
    v_mfma_f32_16x16x32_bf16 v[32:35], v[64:67], a[128:131], 0
    v_mfma_f32_16x16x32_bf16 v[36:39], v[68:71], a[128:131], 0
    v_mfma_f32_16x16x32_bf16 v[40:43], v[64:67], a[192:195], 0
    v_mfma_f32_16x16x32_bf16 v[44:47], v[68:71], a[192:195], 0
    ds_read_b128 v[96:99], v14 offset:8192
    ds_read_b128 v[100:103], v14 offset:9216
    s_waitcnt lgkmcnt(6)
    v_mfma_f32_16x16x32_bf16 v[16:19], a[4:7], v[72:75], v[16:19]
    v_mfma_f32_16x16x32_bf16 v[20:23], a[4:7], v[76:79], v[20:23]
    v_mfma_f32_16x16x32_bf16 v[24:27], a[68:71], v[72:75], v[24:27]
    v_mfma_f32_16x16x32_bf16 v[28:31], a[68:71], v[76:79], v[28:31]
    v_mfma_f32_16x16x32_bf16 v[32:35], v[72:75], a[132:135], v[32:35]
    v_mfma_f32_16x16x32_bf16 v[36:39], v[76:79], a[132:135], v[36:39]
    v_mfma_f32_16x16x32_bf16 v[40:43], v[72:75], a[196:199], v[40:43]
    v_mfma_f32_16x16x32_bf16 v[44:47], v[76:79], a[196:199], v[44:47]
    ds_read_b128 v[104:107], v14 offset:10240
    ds_read_b128 v[108:111], v14 offset:11264
    s_waitcnt lgkmcnt(6)
    v_mfma_f32_16x16x32_bf16 v[16:19], a[8:11], v[80:83], v[16:19]
    v_mfma_f32_16x16x32_bf16 v[20:23], a[8:11], v[84:87], v[20:23]
    v_mfma_f32_16x16x32_bf16 v[24:27], a[72:75], v[80:83], v[24:27]
    v_mfma_f32_16x16x32_bf16 v[28:31], a[72:75], v[84:87], v[28:31]
    v_mfma_f32_16x16x32_bf16 v[32:35], v[80:83], a[136:139], v[32:35]
    v_mfma_f32_16x16x32_bf16 v[36:39], v[84:87], a[136:139], v[36:39]
    v_mfma_f32_16x16x32_bf16 v[40:43], v[80:83], a[200:203], v[40:43]
    v_mfma_f32_16x16x32_bf16 v[44:47], v[84:87], a[200:203], v[44:47]
    ds_read_b128 v[112:115], v14 offset:12288
    ds_read_b128 v[116:119], v14 offset:13312
    s_waitcnt lgkmcnt(6)
    v_mfma_f32_16x16x32_bf16 v[16:19], a[12:15], v[88:91], v[16:19]
    v_mfma_f32_16x16x32_bf16 v[20:23], a[12:15], v[92:95], v[20:23]
    v_mfma_f32_16x16x32_bf16 v[24:27], a[76:79], v[88:91], v[24:27]
    v_mfma_f32_16x16x32_bf16 v[28:31], a[76:79], v[92:95], v[28:31]
    v_mfma_f32_16x16x32_bf16 v[32:35], v[88:91], a[140:143], v[32:35]
    v_mfma_f32_16x16x32_bf16 v[36:39], v[92:95], a[140:143], v[36:39]
    v_mfma_f32_16x16x32_bf16 v[40:43], v[88:91], a[204:207], v[40:43]
    v_mfma_f32_16x16x32_bf16 v[44:47], v[92:95], a[204:207], v[44:47]
    ds_read_b128 v[120:123], v14 offset:14336
    ds_read_b128 v[124:127], v14 offset:15360
    s_waitcnt lgkmcnt(6)
    v_mfma_f32_16x16x32_bf16 v[16:19], a[16:19], v[96:99], v[16:19]
    v_mfma_f32_16x16x32_bf16 v[20:23], a[16:19], v[100:103], v[20:23]
    v_mfma_f32_16x16x32_bf16 v[24:27], a[80:83], v[96:99], v[24:27]
    v_mfma_f32_16x16x32_bf16 v[28:31], a[80:83], v[100:103], v[28:31]
    v_mfma_f32_16x16x32_bf16 v[32:35], v[96:99], a[144:147], v[32:35]
    v_mfma_f32_16x16x32_bf16 v[36:39], v[100:103], a[144:147], v[36:39]
    v_mfma_f32_16x16x32_bf16 v[40:43], v[96:99], a[208:211], v[40:43]
    v_mfma_f32_16x16x32_bf16 v[44:47], v[100:103], a[208:211], v[44:47]
    ds_read_b128 v[64:67], v14 offset:16384
    ds_read_b128 v[68:71], v14 offset:17408
    s_waitcnt lgkmcnt(6)
    v_mfma_f32_16x16x32_bf16 v[16:19], a[20:23], v[104:107], v[16:19]
    v_mfma_f32_16x16x32_bf16 v[20:23], a[20:23], v[108:111], v[20:23]
    v_mfma_f32_16x16x32_bf16 v[24:27], a[84:87], v[104:107], v[24:27]
    v_mfma_f32_16x16x32_bf16 v[28:31], a[84:87], v[108:111], v[28:31]
    v_mfma_f32_16x16x32_bf16 v[32:35], v[104:107], a[148:151], v[32:35]
    v_mfma_f32_16x16x32_bf16 v[36:39], v[108:111], a[148:151], v[36:39]
    v_mfma_f32_16x16x32_bf16 v[40:43], v[104:107], a[212:215], v[40:43]
    v_mfma_f32_16x16x32_bf16 v[44:47], v[108:111], a[212:215], v[44:47]
    ds_read_b128 v[72:75], v14 offset:18432
    ds_read_b128 v[76:79], v14 offset:19456
    s_waitcnt lgkmcnt(6)
    v_mfma_f32_16x16x32_bf16 v[16:19], a[24:27], v[112:115], v[16:19]
    v_mfma_f32_16x16x32_bf16 v[20:23], a[24:27], v[116:119], v[20:23]
    v_mfma_f32_16x16x32_bf16 v[24:27], a[88:91], v[112:115], v[24:27]
    v_mfma_f32_16x16x32_bf16 v[28:31], a[88:91], v[116:119], v[28:31]
    v_mfma_f32_16x16x32_bf16 v[32:35], v[112:115], a[152:155], v[32:35]
    v_mfma_f32_16x16x32_bf16 v[36:39], v[116:119], a[152:155], v[36:39]
    v_mfma_f32_16x16x32_bf16 v[40:43], v[112:115], a[216:219], v[40:43]
    v_mfma_f32_16x16x32_bf16 v[44:47], v[116:119], a[216:219], v[44:47]
    ds_read_b128 v[80:83], v14 offset:20480
    ds_read_b128 v[84:87], v14 offset:21504
    s_waitcnt lgkmcnt(6)
    v_mfma_f32_16x16x32_bf16 v[16:19], a[28:31], v[120:123], v[16:19]
    v_mfma_f32_16x16x32_bf16 v[20:23], a[28:31], v[124:127], v[20:23]
    v_mfma_f32_16x16x32_bf16 v[24:27], a[92:95], v[120:123], v[24:27]
    v_mfma_f32_16x16x32_bf16 v[28:31], a[92:95], v[124:127], v[28:31]
    v_mfma_f32_16x16x32_bf16 v[32:35], v[120:123], a[156:159], v[32:35]
    v_mfma_f32_16x16x32_bf16 v[36:39], v[124:127], a[156:159], v[36:39]
    v_mfma_f32_16x16x32_bf16 v[40:43], v[120:123], a[220:223], v[40:43]
    v_mfma_f32_16x16x32_bf16 v[44:47], v[124:127], a[220:223], v[44:47]
    ds_read_b128 v[88:91], v14 offset:22528
    ds_read_b128 v[92:95], v14 offset:23552
    s_waitcnt lgkmcnt(6)
    v_mfma_f32_16x16x32_bf16 v[16:19], a[32:35], v[64:67], v[16:19]
    v_mfma_f32_16x16x32_bf16 v[20:23], a[32:35], v[68:71], v[20:23]
    v_mfma_f32_16x16x32_bf16 v[24:27], a[96:99], v[64:67], v[24:27]
    v_mfma_f32_16x16x32_bf16 v[28:31], a[96:99], v[68:71], v[28:31]
    v_mfma_f32_16x16x32_bf16 v[32:35], v[64:67], a[160:163], v[32:35]
    v_mfma_f32_16x16x32_bf16 v[36:39], v[68:71], a[160:163], v[36:39]
    v_mfma_f32_16x16x32_bf16 v[40:43], v[64:67], a[224:227], v[40:43]
    v_mfma_f32_16x16x32_bf16 v[44:47], v[68:71], a[224:227], v[44:47]
    ds_read_b128 v[96:99], v14 offset:24576
    ds_read_b128 v[100:103], v14 offset:25600
    s_waitcnt lgkmcnt(6)
    v_mfma_f32_16x16x32_bf16 v[16:19], a[36:39], v[72:75], v[16:19]
    v_mfma_f32_16x16x32_bf16 v[20:23], a[36:39], v[76:79], v[20:23]
    v_mfma_f32_16x16x32_bf16 v[24:27], a[100:103], v[72:75], v[24:27]
    v_mfma_f32_16x16x32_bf16 v[28:31], a[100:103], v[76:79], v[28:31]
    v_mfma_f32_16x16x32_bf16 v[32:35], v[72:75], a[164:167], v[32:35]
    v_mfma_f32_16x16x32_bf16 v[36:39], v[76:79], a[164:167], v[36:39]
    v_mfma_f32_16x16x32_bf16 v[40:43], v[72:75], a[228:231], v[40:43]
    v_mfma_f32_16x16x32_bf16 v[44:47], v[76:79], a[228:231], v[44:47]
    ds_read_b128 v[104:107], v14 offset:26624
    ds_read_b128 v[108:111], v14 offset:27648
    s_waitcnt lgkmcnt(6)
    v_mfma_f32_16x16x32_bf16 v[16:19], a[40:43], v[80:83], v[16:19]
    v_mfma_f32_16x16x32_bf16 v[20:23], a[40:43], v[84:87], v[20:23]
    v_mfma_f32_16x16x32_bf16 v[24:27], a[104:107], v[80:83], v[24:27]
    v_mfma_f32_16x16x32_bf16 v[28:31], a[104:107], v[84:87], v[28:31]
    v_mfma_f32_16x16x32_bf16 v[32:35], v[80:83], a[168:171], v[32:35]
    v_mfma_f32_16x16x32_bf16 v[36:39], v[84:87], a[168:171], v[36:39]
    v_mfma_f32_16x16x32_bf16 v[40:43], v[80:83], a[232:235], v[40:43]
    v_mfma_f32_16x16x32_bf16 v[44:47], v[84:87], a[232:235], v[44:47]
    ds_read_b128 v[112:115], v14 offset:28672
    ds_read_b128 v[116:119], v14 offset:29696
    s_waitcnt lgkmcnt(6)
    v_mfma_f32_16x16x32_bf16 v[16:19], a[44:47], v[88:91], v[16:19]
    v_mfma_f32_16x16x32_bf16 v[20:23], a[44:47], v[92:95], v[20:23]
    v_mfma_f32_16x16x32_bf16 v[24:27], a[108:111], v[88:91], v[24:27]
    v_mfma_f32_16x16x32_bf16 v[28:31], a[108:111], v[92:95], v[28:31]
    v_mfma_f32_16x16x32_bf16 v[32:35], v[88:91], a[172:175], v[32:35]
    v_mfma_f32_16x16x32_bf16 v[36:39], v[92:95], a[172:175], v[36:39]
    v_mfma_f32_16x16x32_bf16 v[40:43], v[88:91], a[236:239], v[40:43]
    v_mfma_f32_16x16x32_bf16 v[44:47], v[92:95], a[236:239], v[44:47]
    ds_read_b128 v[120:123], v14 offset:30720
    ds_read_b128 v[124:127], v14 offset:31744
    s_waitcnt lgkmcnt(6)
    v_mfma_f32_16x16x32_bf16 v[16:19], a[48:51], v[96:99], v[16:19]
    v_mfma_f32_16x16x32_bf16 v[20:23], a[48:51], v[100:103], v[20:23]
    v_mfma_f32_16x16x32_bf16 v[24:27], a[112:115], v[96:99], v[24:27]
    v_mfma_f32_16x16x32_bf16 v[28:31], a[112:115], v[100:103], v[28:31]
    v_mfma_f32_16x16x32_bf16 v[32:35], v[96:99], a[176:179], v[32:35]
    v_mfma_f32_16x16x32_bf16 v[36:39], v[100:103], a[176:179], v[36:39]
    v_mfma_f32_16x16x32_bf16 v[40:43], v[96:99], a[240:243], v[40:43]
    v_mfma_f32_16x16x32_bf16 v[44:47], v[100:103], a[240:243], v[44:47]
    s_waitcnt lgkmcnt(4)
    v_mfma_f32_16x16x32_bf16 v[16:19], a[52:55], v[104:107], v[16:19]
    v_mfma_f32_16x16x32_bf16 v[20:23], a[52:55], v[108:111], v[20:23]
    v_mfma_f32_16x16x32_bf16 v[24:27], a[116:119], v[104:107], v[24:27]
    v_mfma_f32_16x16x32_bf16 v[28:31], a[116:119], v[108:111], v[28:31]
    v_mfma_f32_16x16x32_bf16 v[32:35], v[104:107], a[180:183], v[32:35]
    v_mfma_f32_16x16x32_bf16 v[36:39], v[108:111], a[180:183], v[36:39]
    v_mfma_f32_16x16x32_bf16 v[40:43], v[104:107], a[244:247], v[40:43]
    v_mfma_f32_16x16x32_bf16 v[44:47], v[108:111], a[244:247], v[44:47]
    s_waitcnt lgkmcnt(2)
    v_mfma_f32_16x16x32_bf16 v[16:19], a[56:59], v[112:115], v[16:19]
    v_mfma_f32_16x16x32_bf16 v[20:23], a[56:59], v[116:119], v[20:23]
    v_mfma_f32_16x16x32_bf16 v[24:27], a[120:123], v[112:115], v[24:27]
    v_mfma_f32_16x16x32_bf16 v[28:31], a[120:123], v[116:119], v[28:31]
    v_mfma_f32_16x16x32_bf16 v[32:35], v[112:115], a[184:187], v[32:35]
    v_mfma_f32_16x16x32_bf16 v[36:39], v[116:119], a[184:187], v[36:39]
    v_mfma_f32_16x16x32_bf16 v[40:43], v[112:115], a[248:251], v[40:43]
    v_mfma_f32_16x16x32_bf16 v[44:47], v[116:119], a[248:251], v[44:47]
    s_waitcnt lgkmcnt(0)
    v_mfma_f32_16x16x32_bf16 v[16:19], a[60:63], v[120:123], v[16:19]
    v_mfma_f32_16x16x32_bf16 v[20:23], a[60:63], v[124:127], v[20:23]
    v_mfma_f32_16x16x32_bf16 v[24:27], a[124:127], v[120:123], v[24:27]
    v_mfma_f32_16x16x32_bf16 v[28:31], a[124:127], v[124:127], v[28:31]
    v_mfma_f32_16x16x32_bf16 v[32:35], v[120:123], a[188:191], v[32:35]
    v_mfma_f32_16x16x32_bf16 v[36:39], v[124:127], a[188:191], v[36:39]
    v_mfma_f32_16x16x32_bf16 v[40:43], v[120:123], a[252:255], v[40:43]
    v_mfma_f32_16x16x32_bf16 v[44:47], v[124:127], a[252:255], v[44:47]
    s_lshl_b32 s28, s24, 6
    s_add_u32 s36, s28, s33
    s_mul_i32 s28, s36, 24576
    s_add_u32 s28, s28, 0x200000
    s_add_u32 s29, s28, 0x1000
    s_add_u32 s37, s28, 0x2000
    s_add_u32 s38, s28, 0x4000
    s_add_u32 s39, s28, 0x5000
    s_nop 7
    v_cvt_pk_bf16_f32 v16, v16, v17
    v_cvt_pk_bf16_f32 v17, v18, v19
    v_cvt_pk_bf16_f32 v18, v24, v25
    v_cvt_pk_bf16_f32 v19, v26, v27
    buffer_store_dwordx4 v[16:19], v12, s[4:7], s28 offen sc0 sc1
    v_cvt_pk_bf16_f32 v20, v20, v21
    v_cvt_pk_bf16_f32 v21, v22, v23
    v_cvt_pk_bf16_f32 v22, v28, v29
    v_cvt_pk_bf16_f32 v23, v30, v31
    buffer_store_dwordx4 v[20:23], v12, s[4:7], s29 offen sc0 sc1
    v_cvt_pk_bf16_f32 v32, v32, v33
    v_cvt_pk_bf16_f32 v33, v34, v35
    v_cvt_pk_bf16_f32 v34, v36, v37
    v_cvt_pk_bf16_f32 v35, v38, v39
    buffer_store_dwordx4 v[32:35], v13, s[4:7], s37 offen offset:0 sc0 sc1
    v_cvt_pk_bf16_f32 v40, v40, v41
    v_cvt_pk_bf16_f32 v41, v42, v43
    v_cvt_pk_bf16_f32 v42, v44, v45
    v_cvt_pk_bf16_f32 v43, v46, v47
    buffer_store_dwordx4 v[40:43], v13, s[4:7], s37 offen offset:1024 sc0 sc1
    ds_read_b64_tr_b16 v[128:129], v6 offset:0
    ds_read_b64_tr_b16 v[130:131], v6 offset:1024
    ds_read_b64_tr_b16 v[192:193], v7 offset:0
    ds_read_b64_tr_b16 v[194:195], v7 offset:1024
    ds_read_b64_tr_b16 v[132:133], v6 offset:8192
    ds_read_b64_tr_b16 v[134:135], v6 offset:9216
    ds_read_b64_tr_b16 v[196:197], v7 offset:8192
    ds_read_b64_tr_b16 v[198:199], v7 offset:9216
    ds_read_b64_tr_b16 v[136:137], v6 offset:16384
    ds_read_b64_tr_b16 v[138:139], v6 offset:17408
    ds_read_b64_tr_b16 v[200:201], v7 offset:16384
    ds_read_b64_tr_b16 v[202:203], v7 offset:17408
    ds_read_b64_tr_b16 v[140:141], v6 offset:24576
    ds_read_b64_tr_b16 v[142:143], v6 offset:25600
    ds_read_b64_tr_b16 v[204:205], v7 offset:24576
    ds_read_b64_tr_b16 v[206:207], v7 offset:25600
    ds_read_b64_tr_b16 v[144:145], v6 offset:32768
    ds_read_b64_tr_b16 v[146:147], v6 offset:33792
    ds_read_b64_tr_b16 v[208:209], v7 offset:32768
    ds_read_b64_tr_b16 v[210:211], v7 offset:33792
    ds_read_b64_tr_b16 v[148:149], v6 offset:40960
    ds_read_b64_tr_b16 v[150:151], v6 offset:41984
    ds_read_b64_tr_b16 v[212:213], v7 offset:40960
    ds_read_b64_tr_b16 v[214:215], v7 offset:41984
    ds_read_b64_tr_b16 v[152:153], v6 offset:49152
    ds_read_b64_tr_b16 v[154:155], v6 offset:50176
    ds_read_b64_tr_b16 v[216:217], v7 offset:49152
    ds_read_b64_tr_b16 v[218:219], v7 offset:50176
    ds_read_b64_tr_b16 v[156:157], v6 offset:57344
    ds_read_b64_tr_b16 v[158:159], v6 offset:58368
    ds_read_b64_tr_b16 v[220:221], v7 offset:57344
    ds_read_b64_tr_b16 v[222:223], v7 offset:58368
    s_waitcnt lgkmcnt(0)
    s_barrier
    s_cmp_eq_u32 s3, 0
    s_cbranch_scc1 L_lw_4a
    s_waitcnt vmcnt(0)
    v_readfirstlane_b32 s28, v61
    s_cmp_lg_u32 s28, 0
    s_cbranch_scc1 L_lw_4c
    v_mov_b32 v60, 32
    v_mov_b32 v56, s23
    v_mov_b32 v57, 0
    s_mov_b64 exec, 1
    buffer_atomic_cmpswap v[56:57], v60, s[8:11], 0 offen sc0 sc1
    s_mov_b64 exec, -1
    s_waitcnt vmcnt(0)
    v_readfirstlane_b32 s28, v56
L_lw_4c:
    v_mov_b32 v60, 0x100
    s_cmp_eq_u32 s28, 0
    s_cselect_b32 s28, s23, s28
    v_mov_b32 v59, s28
    s_mov_b64 exec, 1
    ds_write_b64 v60, v[58:59]
    s_mov_b64 exec, -1
    s_waitcnt lgkmcnt(0)
L_lw_4a:
    s_waitcnt vmcnt(0)
L_lw_4b:
    s_barrier
    s_cmp_eq_u32 s101, 0
    s_cbranch_scc1 L_vf_5
    v_mov_b32 v60, 0x100
    ds_read_b64 v[58:59], v60
    s_waitcnt lgkmcnt(0)
    v_readfirstlane_b32 s28, v58
    v_readfirstlane_b32 s23, v59
    s_bitcmp1_b32 s28, s22
    s_cbranch_scc1 L_slow
L_vf_5:
    s_cmp_lg_u32 s20, 0
    s_cbranch_scc1 L_w1ef
    s_lshl_b32 s28, s36, 2
    s_add_u32 s28, s28, 0x50000
    v_mov_b32 v16, s23
    v_mov_b32 v15, 0
    s_mov_b64 exec, 1
    buffer_store_dword v16, v15, s[4:7], s28 offen sc0 sc1
    s_mov_b64 exec, -1
L_w1ef:
    ds_read_b64_tr_b16 v[160:161], v8 offset:0
    ds_read_b64_tr_b16 v[162:163], v8 offset:1024
    ds_read_b64_tr_b16 v[224:225], v9 offset:0
    ds_read_b64_tr_b16 v[226:227], v9 offset:1024
    ds_read_b64_tr_b16 v[164:165], v8 offset:8192
    ds_read_b64_tr_b16 v[166:167], v8 offset:9216
    ds_read_b64_tr_b16 v[228:229], v9 offset:8192
    ds_read_b64_tr_b16 v[230:231], v9 offset:9216
    ds_read_b64_tr_b16 v[168:169], v8 offset:16384
    ds_read_b64_tr_b16 v[170:171], v8 offset:17408
    ds_read_b64_tr_b16 v[232:233], v9 offset:16384
    ds_read_b64_tr_b16 v[234:235], v9 offset:17408
    ds_read_b64_tr_b16 v[172:173], v8 offset:24576
    ds_read_b64_tr_b16 v[174:175], v8 offset:25600
    ds_read_b64_tr_b16 v[236:237], v9 offset:24576
    ds_read_b64_tr_b16 v[238:239], v9 offset:25600
    ds_read_b64_tr_b16 v[176:177], v8 offset:32768
    ds_read_b64_tr_b16 v[178:179], v8 offset:33792
    ds_read_b64_tr_b16 v[240:241], v9 offset:32768
    ds_read_b64_tr_b16 v[242:243], v9 offset:33792
    ds_read_b64_tr_b16 v[180:181], v8 offset:40960
    ds_read_b64_tr_b16 v[182:183], v8 offset:41984
    ds_read_b64_tr_b16 v[244:245], v9 offset:40960
    ds_read_b64_tr_b16 v[246:247], v9 offset:41984
    ds_read_b64_tr_b16 v[184:185], v8 offset:49152
    ds_read_b64_tr_b16 v[186:187], v8 offset:50176
    ds_read_b64_tr_b16 v[248:249], v9 offset:49152
    ds_read_b64_tr_b16 v[250:251], v9 offset:50176
    ds_read_b64_tr_b16 v[188:189], v8 offset:57344
    ds_read_b64_tr_b16 v[190:191], v8 offset:58368
    ds_read_b64_tr_b16 v[252:253], v9 offset:57344
    ds_read_b64_tr_b16 v[254:255], v9 offset:58368
    s_waitcnt lgkmcnt(0)
    s_barrier
L_w1loop:
    s_add_u32 s35, s33, 7
    s_min_u32 s35, s35, 63
    s_lshl_b32 s35, s35, 15
    s_xor_b32 s44, s44, 0x20000
    ds_read_b128 v[64:67], v14 offset:0
    ds_read_b128 v[68:71], v14 offset:1024
    ds_read_b128 v[72:75], v14 offset:2048
    ds_read_b128 v[76:79], v14 offset:3072
    ds_read_b128 v[80:83], v14 offset:4096
    ds_read_b128 v[84:87], v14 offset:5120
    ds_read_b128 v[88:91], v14 offset:6144
    ds_read_b128 v[92:95], v14 offset:7168
    s_add_u32 m0, s44, 0
    s_nop 0
    buffer_load_dwordx4 v10, s[40:43], s35 offen offset:0 lds
    s_add_u32 m0, s44, 1024
    s_nop 0
    buffer_load_dwordx4 v11, s[40:43], s35 offen offset:0 lds
    s_add_u32 m0, s44, 1984
    s_nop 0
    buffer_load_dwordx4 v10, s[40:43], s35 offen offset:64 lds
    s_add_u32 m0, s44, 3008
    s_nop 0
    buffer_load_dwordx4 v11, s[40:43], s35 offen offset:64 lds
    s_add_u32 m0, s44, 3968
    s_nop 0
    buffer_load_dwordx4 v10, s[40:43], s35 offen offset:128 lds
    s_add_u32 m0, s44, 4992
    s_nop 0
    buffer_load_dwordx4 v11, s[40:43], s35 offen offset:128 lds
    s_add_u32 m0, s44, 5952
    s_nop 0
    buffer_load_dwordx4 v10, s[40:43], s35 offen offset:192 lds
    s_add_u32 m0, s44, 6976
    s_nop 0
    buffer_load_dwordx4 v11, s[40:43], s35 offen offset:192 lds
    s_waitcnt lgkmcnt(6)
    v_mfma_f32_16x16x32_bf16 v[16:19], a[0:3], v[64:67], 0
    v_mfma_f32_16x16x32_bf16 v[20:23], a[0:3], v[68:71], 0
    v_mfma_f32_16x16x32_bf16 v[24:27], a[64:67], v[64:67], 0
    v_mfma_f32_16x16x32_bf16 v[28:31], a[64:67], v[68:71], 0
    v_mfma_f32_16x16x32_bf16 v[32:35], v[64:67], a[128:131], 0
    v_mfma_f32_16x16x32_bf16 v[36:39], v[68:71], a[128:131], 0
    v_mfma_f32_16x16x32_bf16 v[40:43], v[64:67], a[192:195], 0
    v_mfma_f32_16x16x32_bf16 v[44:47], v[68:71], a[192:195], 0
    v_mfma_f32_16x16x32_bf16 v[48:51], v[128:131], v[64:67], 0
    v_mfma_f32_16x16x32_bf16 v[52:55], v[128:131], v[68:71], 0
    v_mfma_f32_16x16x32_bf16 v[56:59], v[192:195], v[64:67], 0
    v_mfma_f32_16x16x32_bf16 v[60:63], v[192:195], v[68:71], 0
    ds_read_b128 v[96:99], v14 offset:8192
    ds_read_b128 v[100:103], v14 offset:9216
    s_waitcnt lgkmcnt(6)
    v_mfma_f32_16x16x32_bf16 v[16:19], a[4:7], v[72:75], v[16:19]
    v_mfma_f32_16x16x32_bf16 v[20:23], a[4:7], v[76:79], v[20:23]
    v_mfma_f32_16x16x32_bf16 v[24:27], a[68:71], v[72:75], v[24:27]
    v_mfma_f32_16x16x32_bf16 v[28:31], a[68:71], v[76:79], v[28:31]
    v_mfma_f32_16x16x32_bf16 v[32:35], v[72:75], a[132:135], v[32:35]
    v_mfma_f32_16x16x32_bf16 v[36:39], v[76:79], a[132:135], v[36:39]
    v_mfma_f32_16x16x32_bf16 v[40:43], v[72:75], a[196:199], v[40:43]
    v_mfma_f32_16x16x32_bf16 v[44:47], v[76:79], a[196:199], v[44:47]
    v_mfma_f32_16x16x32_bf16 v[48:51], v[132:135], v[72:75], v[48:51]
    v_mfma_f32_16x16x32_bf16 v[52:55], v[132:135], v[76:79], v[52:55]
    v_mfma_f32_16x16x32_bf16 v[56:59], v[196:199], v[72:75], v[56:59]
    v_mfma_f32_16x16x32_bf16 v[60:63], v[196:199], v[76:79], v[60:63]
    ds_read_b128 v[104:107], v14 offset:10240
    ds_read_b128 v[108:111], v14 offset:11264
    s_waitcnt lgkmcnt(6)
    v_mfma_f32_16x16x32_bf16 v[16:19], a[8:11], v[80:83], v[16:19]
    v_mfma_f32_16x16x32_bf16 v[20:23], a[8:11], v[84:87], v[20:23]
    v_mfma_f32_16x16x32_bf16 v[24:27], a[72:75], v[80:83], v[24:27]
    v_mfma_f32_16x16x32_bf16 v[28:31], a[72:75], v[84:87], v[28:31]
    v_mfma_f32_16x16x32_bf16 v[32:35], v[80:83], a[136:139], v[32:35]
    v_mfma_f32_16x16x32_bf16 v[36:39], v[84:87], a[136:139], v[36:39]
    v_mfma_f32_16x16x32_bf16 v[40:43], v[80:83], a[200:203], v[40:43]
    v_mfma_f32_16x16x32_bf16 v[44:47], v[84:87], a[200:203], v[44:47]
    v_mfma_f32_16x16x32_bf16 v[48:51], v[136:139], v[80:83], v[48:51]
    v_mfma_f32_16x16x32_bf16 v[52:55], v[136:139], v[84:87], v[52:55]
    v_mfma_f32_16x16x32_bf16 v[56:59], v[200:203], v[80:83], v[56:59]
    v_mfma_f32_16x16x32_bf16 v[60:63], v[200:203], v[84:87], v[60:63]
    ds_read_b128 v[112:115], v14 offset:12288
    ds_read_b128 v[116:119], v14 offset:13312
    s_waitcnt lgkmcnt(6)
    v_mfma_f32_16x16x32_bf16 v[16:19], a[12:15], v[88:91], v[16:19]
    v_mfma_f32_16x16x32_bf16 v[20:23], a[12:15], v[92:95], v[20:23]
    v_mfma_f32_16x16x32_bf16 v[24:27], a[76:79], v[88:91], v[24:27]
    v_mfma_f32_16x16x32_bf16 v[28:31], a[76:79], v[92:95], v[28:31]
    v_mfma_f32_16x16x32_bf16 v[32:35], v[88:91], a[140:143], v[32:35]
    v_mfma_f32_16x16x32_bf16 v[36:39], v[92:95], a[140:143], v[36:39]
    v_mfma_f32_16x16x32_bf16 v[40:43], v[88:91], a[204:207], v[40:43]
    v_mfma_f32_16x16x32_bf16 v[44:47], v[92:95], a[204:207], v[44:47]
    v_mfma_f32_16x16x32_bf16 v[48:51], v[140:143], v[88:91], v[48:51]
    v_mfma_f32_16x16x32_bf16 v[52:55], v[140:143], v[92:95], v[52:55]
    v_mfma_f32_16x16x32_bf16 v[56:59], v[204:207], v[88:91], v[56:59]
    v_mfma_f32_16x16x32_bf16 v[60:63], v[204:207], v[92:95], v[60:63]
    ds_read_b128 v[120:123], v14 offset:14336
    ds_read_b128 v[124:127], v14 offset:15360
    s_waitcnt lgkmcnt(6)
    v_mfma_f32_16x16x32_bf16 v[16:19], a[16:19], v[96:99], v[16:19]
    v_mfma_f32_16x16x32_bf16 v[20:23], a[16:19], v[100:103], v[20:23]
    v_mfma_f32_16x16x32_bf16 v[24:27], a[80:83], v[96:99], v[24:27]
    v_mfma_f32_16x16x32_bf16 v[28:31], a[80:83], v[100:103], v[28:31]
    v_mfma_f32_16x16x32_bf16 v[32:35], v[96:99], a[144:147], v[32:35]
    v_mfma_f32_16x16x32_bf16 v[36:39], v[100:103], a[144:147], v[36:39]
    v_mfma_f32_16x16x32_bf16 v[40:43], v[96:99], a[208:211], v[40:43]
    v_mfma_f32_16x16x32_bf16 v[44:47], v[100:103], a[208:211], v[44:47]
    v_mfma_f32_16x16x32_bf16 v[48:51], v[144:147], v[96:99], v[48:51]
    v_mfma_f32_16x16x32_bf16 v[52:55], v[144:147], v[100:103], v[52:55]
    v_mfma_f32_16x16x32_bf16 v[56:59], v[208:211], v[96:99], v[56:59]
    v_mfma_f32_16x16x32_bf16 v[60:63], v[208:211], v[100:103], v[60:63]
    ds_read_b128 v[64:67], v14 offset:16384
    ds_read_b128 v[68:71], v14 offset:17408
    s_waitcnt lgkmcnt(6)
    v_mfma_f32_16x16x32_bf16 v[16:19], a[20:23], v[104:107], v[16:19]
    v_mfma_f32_16x16x32_bf16 v[20:23], a[20:23], v[108:111], v[20:23]
    v_mfma_f32_16x16x32_bf16 v[24:27], a[84:87], v[104:107], v[24:27]
    v_mfma_f32_16x16x32_bf16 v[28:31], a[84:87], v[108:111], v[28:31]
    v_mfma_f32_16x16x32_bf16 v[32:35], v[104:107], a[148:151], v[32:35]
    v_mfma_f32_16x16x32_bf16 v[36:39], v[108:111], a[148:151], v[36:39]
    v_mfma_f32_16x16x32_bf16 v[40:43], v[104:107], a[212:215], v[40:43]
    v_mfma_f32_16x16x32_bf16 v[44:47], v[108:111], a[212:215], v[44:47]
    v_mfma_f32_16x16x32_bf16 v[48:51], v[148:151], v[104:107], v[48:51]
    v_mfma_f32_16x16x32_bf16 v[52:55], v[148:151], v[108:111], v[52:55]
    v_mfma_f32_16x16x32_bf16 v[56:59], v[212:215], v[104:107], v[56:59]
    v_mfma_f32_16x16x32_bf16 v[60:63], v[212:215], v[108:111], v[60:63]
    ds_read_b128 v[72:75], v14 offset:18432
    ds_read_b128 v[76:79], v14 offset:19456
    s_waitcnt lgkmcnt(6)
    v_mfma_f32_16x16x32_bf16 v[16:19], a[24:27], v[112:115], v[16:19]
    v_mfma_f32_16x16x32_bf16 v[20:23], a[24:27], v[116:119], v[20:23]
    v_mfma_f32_16x16x32_bf16 v[24:27], a[88:91], v[112:115], v[24:27]
    v_mfma_f32_16x16x32_bf16 v[28:31], a[88:91], v[116:119], v[28:31]
    v_mfma_f32_16x16x32_bf16 v[32:35], v[112:115], a[152:155], v[32:35]
    v_mfma_f32_16x16x32_bf16 v[36:39], v[116:119], a[152:155], v[36:39]
    v_mfma_f32_16x16x32_bf16 v[40:43], v[112:115], a[216:219], v[40:43]
    v_mfma_f32_16x16x32_bf16 v[44:47], v[116:119], a[216:219], v[44:47]
    v_mfma_f32_16x16x32_bf16 v[48:51], v[152:155], v[112:115], v[48:51]
    v_mfma_f32_16x16x32_bf16 v[52:55], v[152:155], v[116:119], v[52:55]
    v_mfma_f32_16x16x32_bf16 v[56:59], v[216:219], v[112:115], v[56:59]
    v_mfma_f32_16x16x32_bf16 v[60:63], v[216:219], v[116:119], v[60:63]
    ds_read_b128 v[80:83], v14 offset:20480
    ds_read_b128 v[84:87], v14 offset:21504
    s_waitcnt lgkmcnt(6)
    v_mfma_f32_16x16x32_bf16 v[16:19], a[28:31], v[120:123], v[16:19]
    v_mfma_f32_16x16x32_bf16 v[20:23], a[28:31], v[124:127], v[20:23]
    v_mfma_f32_16x16x32_bf16 v[24:27], a[92:95], v[120:123], v[24:27]
    v_mfma_f32_16x16x32_bf16 v[28:31], a[92:95], v[124:127], v[28:31]
    v_mfma_f32_16x16x32_bf16 v[32:35], v[120:123], a[156:159], v[32:35]
    v_mfma_f32_16x16x32_bf16 v[36:39], v[124:127], a[156:159], v[36:39]
    v_mfma_f32_16x16x32_bf16 v[40:43], v[120:123], a[220:223], v[40:43]
    v_mfma_f32_16x16x32_bf16 v[44:47], v[124:127], a[220:223], v[44:47]
    v_mfma_f32_16x16x32_bf16 v[48:51], v[156:159], v[120:123], v[48:51]
    v_mfma_f32_16x16x32_bf16 v[52:55], v[156:159], v[124:127], v[52:55]
    v_mfma_f32_16x16x32_bf16 v[56:59], v[220:223], v[120:123], v[56:59]
    v_mfma_f32_16x16x32_bf16 v[60:63], v[220:223], v[124:127], v[60:63]
    ds_read_b128 v[88:91], v14 offset:22528
    ds_read_b128 v[92:95], v14 offset:23552
    s_waitcnt lgkmcnt(6)
    v_mfma_f32_16x16x32_bf16 v[16:19], a[32:35], v[64:67], v[16:19]
    v_mfma_f32_16x16x32_bf16 v[20:23], a[32:35], v[68:71], v[20:23]
    v_mfma_f32_16x16x32_bf16 v[24:27], a[96:99], v[64:67], v[24:27]
    v_mfma_f32_16x16x32_bf16 v[28:31], a[96:99], v[68:71], v[28:31]
    v_mfma_f32_16x16x32_bf16 v[32:35], v[64:67], a[160:163], v[32:35]
    v_mfma_f32_16x16x32_bf16 v[36:39], v[68:71], a[160:163], v[36:39]
    v_mfma_f32_16x16x32_bf16 v[40:43], v[64:67], a[224:227], v[40:43]
    v_mfma_f32_16x16x32_bf16 v[44:47], v[68:71], a[224:227], v[44:47]
    v_mfma_f32_16x16x32_bf16 v[48:51], v[160:163], v[64:67], v[48:51]
    v_mfma_f32_16x16x32_bf16 v[52:55], v[160:163], v[68:71], v[52:55]
    v_mfma_f32_16x16x32_bf16 v[56:59], v[224:227], v[64:67], v[56:59]
    v_mfma_f32_16x16x32_bf16 v[60:63], v[224:227], v[68:71], v[60:63]
    ds_read_b128 v[96:99], v14 offset:24576
    ds_read_b128 v[100:103], v14 offset:25600
    s_waitcnt lgkmcnt(6)
    v_mfma_f32_16x16x32_bf16 v[16:19], a[36:39], v[72:75], v[16:19]
    v_mfma_f32_16x16x32_bf16 v[20:23], a[36:39], v[76:79], v[20:23]
    v_mfma_f32_16x16x32_bf16 v[24:27], a[100:103], v[72:75], v[24:27]
    v_mfma_f32_16x16x32_bf16 v[28:31], a[100:103], v[76:79], v[28:31]
    v_mfma_f32_16x16x32_bf16 v[32:35], v[72:75], a[164:167], v[32:35]
    v_mfma_f32_16x16x32_bf16 v[36:39], v[76:79], a[164:167], v[36:39]
    v_mfma_f32_16x16x32_bf16 v[40:43], v[72:75], a[228:231], v[40:43]
    v_mfma_f32_16x16x32_bf16 v[44:47], v[76:79], a[228:231], v[44:47]
    v_mfma_f32_16x16x32_bf16 v[48:51], v[164:167], v[72:75], v[48:51]
    v_mfma_f32_16x16x32_bf16 v[52:55], v[164:167], v[76:79], v[52:55]
    v_mfma_f32_16x16x32_bf16 v[56:59], v[228:231], v[72:75], v[56:59]
    v_mfma_f32_16x16x32_bf16 v[60:63], v[228:231], v[76:79], v[60:63]
    ds_read_b128 v[104:107], v14 offset:26624
    ds_read_b128 v[108:111], v14 offset:27648
    s_waitcnt lgkmcnt(6)
    v_mfma_f32_16x16x32_bf16 v[16:19], a[40:43], v[80:83], v[16:19]
    v_mfma_f32_16x16x32_bf16 v[20:23], a[40:43], v[84:87], v[20:23]
    v_mfma_f32_16x16x32_bf16 v[24:27], a[104:107], v[80:83], v[24:27]
    v_mfma_f32_16x16x32_bf16 v[28:31], a[104:107], v[84:87], v[28:31]
    v_mfma_f32_16x16x32_bf16 v[32:35], v[80:83], a[168:171], v[32:35]
    v_mfma_f32_16x16x32_bf16 v[36:39], v[84:87], a[168:171], v[36:39]
    v_mfma_f32_16x16x32_bf16 v[40:43], v[80:83], a[232:235], v[40:43]
    v_mfma_f32_16x16x32_bf16 v[44:47], v[84:87], a[232:235], v[44:47]
    v_mfma_f32_16x16x32_bf16 v[48:51], v[168:171], v[80:83], v[48:51]
    v_mfma_f32_16x16x32_bf16 v[52:55], v[168:171], v[84:87], v[52:55]
    v_mfma_f32_16x16x32_bf16 v[56:59], v[232:235], v[80:83], v[56:59]
    v_mfma_f32_16x16x32_bf16 v[60:63], v[232:235], v[84:87], v[60:63]
    ds_read_b128 v[112:115], v14 offset:28672
    ds_read_b128 v[116:119], v14 offset:29696
    s_waitcnt lgkmcnt(6)
    v_mfma_f32_16x16x32_bf16 v[16:19], a[44:47], v[88:91], v[16:19]
    v_mfma_f32_16x16x32_bf16 v[20:23], a[44:47], v[92:95], v[20:23]
    v_mfma_f32_16x16x32_bf16 v[24:27], a[108:111], v[88:91], v[24:27]
    v_mfma_f32_16x16x32_bf16 v[28:31], a[108:111], v[92:95], v[28:31]
    v_mfma_f32_16x16x32_bf16 v[32:35], v[88:91], a[172:175], v[32:35]
    v_mfma_f32_16x16x32_bf16 v[36:39], v[92:95], a[172:175], v[36:39]
    v_mfma_f32_16x16x32_bf16 v[40:43], v[88:91], a[236:239], v[40:43]
    v_mfma_f32_16x16x32_bf16 v[44:47], v[92:95], a[236:239], v[44:47]
    v_mfma_f32_16x16x32_bf16 v[48:51], v[172:175], v[88:91], v[48:51]
    v_mfma_f32_16x16x32_bf16 v[52:55], v[172:175], v[92:95], v[52:55]
    v_mfma_f32_16x16x32_bf16 v[56:59], v[236:239], v[88:91], v[56:59]
    v_mfma_f32_16x16x32_bf16 v[60:63], v[236:239], v[92:95], v[60:63]
    ds_read_b128 v[120:123], v14 offset:30720
    ds_read_b128 v[124:127], v14 offset:31744
    s_waitcnt lgkmcnt(6)
    v_mfma_f32_16x16x32_bf16 v[16:19], a[48:51], v[96:99], v[16:19]
    v_mfma_f32_16x16x32_bf16 v[20:23], a[48:51], v[100:103], v[20:23]
    v_mfma_f32_16x16x32_bf16 v[24:27], a[112:115], v[96:99], v[24:27]
    v_mfma_f32_16x16x32_bf16 v[28:31], a[112:115], v[100:103], v[28:31]
    v_mfma_f32_16x16x32_bf16 v[32:35], v[96:99], a[176:179], v[32:35]
    v_mfma_f32_16x16x32_bf16 v[36:39], v[100:103], a[176:179], v[36:39]
    v_mfma_f32_16x16x32_bf16 v[40:43], v[96:99], a[240:243], v[40:43]
    v_mfma_f32_16x16x32_bf16 v[44:47], v[100:103], a[240:243], v[44:47]
    v_mfma_f32_16x16x32_bf16 v[48:51], v[176:179], v[96:99], v[48:51]
    v_mfma_f32_16x16x32_bf16 v[52:55], v[176:179], v[100:103], v[52:55]
    v_mfma_f32_16x16x32_bf16 v[56:59], v[240:243], v[96:99], v[56:59]
    v_mfma_f32_16x16x32_bf16 v[60:63], v[240:243], v[100:103], v[60:63]
    s_waitcnt lgkmcnt(4)
    v_mfma_f32_16x16x32_bf16 v[16:19], a[52:55], v[104:107], v[16:19]
    v_mfma_f32_16x16x32_bf16 v[20:23], a[52:55], v[108:111], v[20:23]
    v_mfma_f32_16x16x32_bf16 v[24:27], a[116:119], v[104:107], v[24:27]
    v_mfma_f32_16x16x32_bf16 v[28:31], a[116:119], v[108:111], v[28:31]
    v_mfma_f32_16x16x32_bf16 v[32:35], v[104:107], a[180:183], v[32:35]
    v_mfma_f32_16x16x32_bf16 v[36:39], v[108:111], a[180:183], v[36:39]
    v_mfma_f32_16x16x32_bf16 v[40:43], v[104:107], a[244:247], v[40:43]
    v_mfma_f32_16x16x32_bf16 v[44:47], v[108:111], a[244:247], v[44:47]
    v_mfma_f32_16x16x32_bf16 v[48:51], v[180:183], v[104:107], v[48:51]
    v_mfma_f32_16x16x32_bf16 v[52:55], v[180:183], v[108:111], v[52:55]
    v_mfma_f32_16x16x32_bf16 v[56:59], v[244:247], v[104:107], v[56:59]
    v_mfma_f32_16x16x32_bf16 v[60:63], v[244:247], v[108:111], v[60:63]
    s_waitcnt lgkmcnt(2)
    v_mfma_f32_16x16x32_bf16 v[16:19], a[56:59], v[112:115], v[16:19]
    v_mfma_f32_16x16x32_bf16 v[20:23], a[56:59], v[116:119], v[20:23]
    v_mfma_f32_16x16x32_bf16 v[24:27], a[120:123], v[112:115], v[24:27]
    v_mfma_f32_16x16x32_bf16 v[28:31], a[120:123], v[116:119], v[28:31]
    v_mfma_f32_16x16x32_bf16 v[32:35], v[112:115], a[184:187], v[32:35]
    v_mfma_f32_16x16x32_bf16 v[36:39], v[116:119], a[184:187], v[36:39]
    v_mfma_f32_16x16x32_bf16 v[40:43], v[112:115], a[248:251], v[40:43]
    v_mfma_f32_16x16x32_bf16 v[44:47], v[116:119], a[248:251], v[44:47]
    v_mfma_f32_16x16x32_bf16 v[48:51], v[184:187], v[112:115], v[48:51]
    v_mfma_f32_16x16x32_bf16 v[52:55], v[184:187], v[116:119], v[52:55]
    v_mfma_f32_16x16x32_bf16 v[56:59], v[248:251], v[112:115], v[56:59]
    v_mfma_f32_16x16x32_bf16 v[60:63], v[248:251], v[116:119], v[60:63]
    s_waitcnt lgkmcnt(0)
    v_mfma_f32_16x16x32_bf16 v[16:19], a[60:63], v[120:123], v[16:19]
    v_mfma_f32_16x16x32_bf16 v[20:23], a[60:63], v[124:127], v[20:23]
    v_mfma_f32_16x16x32_bf16 v[24:27], a[124:127], v[120:123], v[24:27]
    v_mfma_f32_16x16x32_bf16 v[28:31], a[124:127], v[124:127], v[28:31]
    v_mfma_f32_16x16x32_bf16 v[32:35], v[120:123], a[188:191], v[32:35]
    v_mfma_f32_16x16x32_bf16 v[36:39], v[124:127], a[188:191], v[36:39]
    v_mfma_f32_16x16x32_bf16 v[40:43], v[120:123], a[252:255], v[40:43]
    v_mfma_f32_16x16x32_bf16 v[44:47], v[124:127], a[252:255], v[44:47]
    v_mfma_f32_16x16x32_bf16 v[48:51], v[188:191], v[120:123], v[48:51]
    v_mfma_f32_16x16x32_bf16 v[52:55], v[188:191], v[124:127], v[52:55]
    v_mfma_f32_16x16x32_bf16 v[56:59], v[252:255], v[120:123], v[56:59]
    v_mfma_f32_16x16x32_bf16 v[60:63], v[252:255], v[124:127], v[60:63]
    s_lshl_b32 s28, s24, 6
    s_add_u32 s36, s28, s33
    s_mul_i32 s28, s36, 24576
    s_add_u32 s28, s28, 0x200000
    s_add_u32 s29, s28, 0x1000
    s_add_u32 s37, s28, 0x2000
    s_add_u32 s38, s28, 0x4000
    s_add_u32 s39, s28, 0x5000
    v_cvt_pk_bf16_f32 v16, v16, v17
    v_cvt_pk_bf16_f32 v17, v18, v19
    v_cvt_pk_bf16_f32 v18, v24, v25
    v_cvt_pk_bf16_f32 v19, v26, v27
    buffer_store_dwordx4 v[16:19], v12, s[4:7], s28 offen sc0 sc1
    v_cvt_pk_bf16_f32 v20, v20, v21
    v_cvt_pk_bf16_f32 v21, v22, v23
    v_cvt_pk_bf16_f32 v22, v28, v29
    v_cvt_pk_bf16_f32 v23, v30, v31
    buffer_store_dwordx4 v[20:23], v12, s[4:7], s29 offen sc0 sc1
    v_cvt_pk_bf16_f32 v32, v32, v33
    v_cvt_pk_bf16_f32 v33, v34, v35
    v_cvt_pk_bf16_f32 v34, v36, v37
    v_cvt_pk_bf16_f32 v35, v38, v39
    buffer_store_dwordx4 v[32:35], v13, s[4:7], s37 offen offset:0 sc0 sc1
    v_cvt_pk_bf16_f32 v40, v40, v41
    v_cvt_pk_bf16_f32 v41, v42, v43
    v_cvt_pk_bf16_f32 v42, v44, v45
    v_cvt_pk_bf16_f32 v43, v46, v47
    buffer_store_dwordx4 v[40:43], v13, s[4:7], s37 offen offset:1024 sc0 sc1
    v_cvt_pk_bf16_f32 v48, v48, v49
    v_cvt_pk_bf16_f32 v49, v50, v51
    v_cvt_pk_bf16_f32 v50, v56, v57
    v_cvt_pk_bf16_f32 v51, v58, v59
    buffer_store_dwordx4 v[48:51], v12, s[4:7], s38 offen
    v_cvt_pk_bf16_f32 v52, v52, v53
    v_cvt_pk_bf16_f32 v53, v54, v55
    v_cvt_pk_bf16_f32 v54, v60, v61
    v_cvt_pk_bf16_f32 v55, v62, v63
    buffer_store_dwordx4 v[52:55], v12, s[4:7], s39 offen
    s_waitcnt vmcnt(0)
    s_barrier
    s_cmp_lg_u32 s20, 0
    s_cbranch_scc1 L_w1nof
    s_lshl_b32 s28, s36, 2
    s_add_u32 s28, s28, 0x50000
    v_mov_b32 v16, s23
    v_mov_b32 v15, 0
    s_mov_b64 exec, 1
    buffer_store_dword v16, v15, s[4:7], s28 offen sc0 sc1
    s_mov_b64 exec, -1
L_w1nof:
    s_add_u32 s33, s33, 7
    v_xor_b32 v14, 0x20000, v14
    s_cmp_lt_u32 s33, 64
    s_cbranch_scc1 L_w1loop
    s_waitcnt vmcnt(0)
    s_cmp_gt_u32 s32, 63
    s_cbranch_scc1 L_pbend
    s_waitcnt vmcnt(0) lgkmcnt(0)
    s_barrier
    s_lshl_b32 s28, s32, 6
    s_add_u32 s30, s84, s28
    s_addc_u32 s31, s85, 0
    s_load_dwordx16 s[48:63], s[30:31], 0
    s_lshl_b32 s33, s32, 4
    s_add_u32 s30, s88, s33
    s_addc_u32 s31, s89, 0
    s_load_dwordx4 s[44:47], s[30:31], 0
    s_mov_b32 s12, s80
    s_and_b32 s13, s81, 0xffff
    s_mov_b32 s14, 0x200000
    s_mov_b32 s15, 0x00020000
    s_mov_b32 s16, s82
    s_and_b32 s17, s83, 0xffff
    s_mov_b32 s18, 0x200000
    s_mov_b32 s19, 0x00020000
    s_lshl_b32 s28, s20, 6
    v_add_u32 v1, s28, v0
    v_lshlrev_b32 v2, 13, v1
    v_add_u32 v2, s33, v2
    v_add_u32 v3, 0x1000, v2
    v_subrev_u32 v4, 0xc00, v2
    buffer_load_dwordx4 v[16:19], v4, s[12:15], 0 offen offset:0
    buffer_load_dwordx4 v[20:23], v4, s[12:15], 0 offen offset:1024
    buffer_load_dwordx4 v[24:27], v4, s[12:15], 0 offen offset:2048
    buffer_load_dwordx4 v[28:31], v2, s[12:15], 0 offen offset:0
    buffer_load_dwordx4 v[32:35], v2, s[12:15], 0 offen offset:1024
    buffer_load_dwordx4 v[36:39], v2, s[12:15], 0 offen offset:2048
    buffer_load_dwordx4 v[40:43], v2, s[12:15], 0 offen offset:3072
    buffer_load_dwordx4 v[44:47], v3, s[12:15], 0 offen offset:0
    buffer_load_dwordx4 v[48:51], v3, s[12:15], 0 offen offset:1024
    buffer_load_dwordx4 v[52:55], v3, s[12:15], 0 offen offset:2048
    buffer_load_dwordx4 v[56:59], v3, s[12:15], 0 offen offset:3072
    buffer_load_dwordx4 v[60:63], v2, s[16:19], 0 offen offset:0
    buffer_load_dwordx4 v[64:67], v2, s[16:19], 0 offen offset:1024
    buffer_load_dwordx4 v[68:71], v2, s[16:19], 0 offen offset:2048
    buffer_load_dwordx4 v[72:75], v2, s[16:19], 0 offen offset:3072
    buffer_load_dwordx4 v[76:79], v3, s[16:19], 0 offen offset:0
    buffer_load_dwordx4 v[80:83], v3, s[16:19], 0 offen offset:1024
    buffer_load_dwordx4 v[84:87], v3, s[16:19], 0 offen offset:2048
    buffer_load_dwordx4 v[88:91], v3, s[16:19], 0 offen offset:3072
    v_mov_b32 v112, 0
    v_mov_b32 v113, 0
    v_mov_b32 v114, 0
    v_mov_b32 v115, 0
    v_lshlrev_b32 v5, 4, v1
    v_cmp_gt_u32 vcc, 160, v1
    v_lshrrev_b32 v6, 2, v1
    v_mul_u32_u24 v6, 80, v6
    s_mov_b64 exec, vcc
    s_cbranch_execz L_pbz
    ds_write_b128 v5, v[112:115] offset:0
    ds_write_b128 v5, v[112:115] offset:7680
    ds_write_b128 v5, v[112:115] offset:15360
    ds_write_b128 v5, v[112:115] offset:23040
    ds_write_b128 v5, v[112:115] offset:30720
    ds_write_b128 v5, v[112:115] offset:38400
    ds_write_b128 v5, v[112:115] offset:46080
    ds_write_b128 v5, v[112:115] offset:53760
L_pbz:
    s_mov_b64 exec, -1
    v_and_b32 v7, 3, v1
    v_lshl_add_u32 v6, v7, 4, v6
    v_add_u32 v6, 2560, v6
    s_waitcnt vmcnt(0) lgkmcnt(0)
    s_lshl_b32 s36, s48, 16
    s_and_b32 s37, s48, 0xffff0000
    s_lshl_b32 s38, s49, 16
    s_and_b32 s39, s49, 0xffff0000
    v_lshlrev_b32 v92, 16, v16
    v_lshlrev_b32 v93, 16, v20
    v_lshlrev_b32 v94, 16, v24
    v_lshlrev_b32 v95, 16, v28
    v_lshlrev_b32 v96, 16, v32
    v_lshlrev_b32 v97, 16, v36
    v_lshlrev_b32 v98, 16, v40
    v_lshlrev_b32 v99, 16, v44
    v_lshlrev_b32 v100, 16, v48
    v_lshlrev_b32 v101, 16, v52
    v_lshlrev_b32 v102, 16, v56
    v_mul_f32 v104, s39, v92
    v_mul_f32 v105, s39, v93
    v_mul_f32 v106, s39, v94
    v_mul_f32 v107, s39, v95
    v_mul_f32 v108, s39, v96
    v_mul_f32 v109, s39, v97
    v_mul_f32 v110, s39, v98
    v_mul_f32 v111, s39, v99
    v_fmac_f32 v104, s38, v93
    v_fmac_f32 v105, s38, v94
    v_fmac_f32 v106, s38, v95
    v_fmac_f32 v107, s38, v96
    v_fmac_f32 v108, s38, v97
    v_fmac_f32 v109, s38, v98
    v_fmac_f32 v110, s38, v99
    v_fmac_f32 v111, s38, v100
    v_fmac_f32 v104, s37, v94
    v_fmac_f32 v105, s37, v95
    v_fmac_f32 v106, s37, v96
    v_fmac_f32 v107, s37, v97
    v_fmac_f32 v108, s37, v98
    v_fmac_f32 v109, s37, v99
    v_fmac_f32 v110, s37, v100
    v_fmac_f32 v111, s37, v101
    v_fmac_f32 v104, s36, v95
    v_fmac_f32 v105, s36, v96
    v_fmac_f32 v106, s36, v97
    v_fmac_f32 v107, s36, v98
    v_fmac_f32 v108, s36, v99
    v_fmac_f32 v109, s36, v100
    v_fmac_f32 v110, s36, v101
    v_fmac_f32 v111, s36, v102
    v_lshlrev_b32 v92, 16, v60
    v_lshlrev_b32 v93, 16, v64
    v_lshlrev_b32 v94, 16, v68
    v_lshlrev_b32 v95, 16, v72
    v_lshlrev_b32 v96, 16, v76
    v_lshlrev_b32 v97, 16, v80
    v_lshlrev_b32 v98, 16, v84
    v_lshlrev_b32 v99, 16, v88
    v_mul_f32 v104, v104, v92
    v_mul_f32 v105, v105, v93
    v_mul_f32 v106, v106, v94
    v_mul_f32 v107, v107, v95
    v_mul_f32 v108, v108, v96
    v_mul_f32 v109, v109, v97
    v_mul_f32 v110, v110, v98
    v_mul_f32 v111, v111, v99
    v_cvt_pk_bf16_f32 v112, v111, v110
    v_cvt_pk_bf16_f32 v113, v109, v108
    v_cvt_pk_bf16_f32 v114, v107, v106
    v_cvt_pk_bf16_f32 v115, v105, v104
    ds_write_b128 v6, v[112:115] offset:0
    s_lshl_b32 s36, s50, 16
    s_and_b32 s37, s50, 0xffff0000
    s_lshl_b32 s38, s51, 16
    s_and_b32 s39, s51, 0xffff0000
    v_and_b32 v92, 0xffff0000, v16
    v_and_b32 v93, 0xffff0000, v20
    v_and_b32 v94, 0xffff0000, v24
    v_and_b32 v95, 0xffff0000, v28
    v_and_b32 v96, 0xffff0000, v32
    v_and_b32 v97, 0xffff0000, v36
    v_and_b32 v98, 0xffff0000, v40
    v_and_b32 v99, 0xffff0000, v44
    v_and_b32 v100, 0xffff0000, v48
    v_and_b32 v101, 0xffff0000, v52
    v_and_b32 v102, 0xffff0000, v56
    v_mul_f32 v104, s39, v92
    v_mul_f32 v105, s39, v93
    v_mul_f32 v106, s39, v94
    v_mul_f32 v107, s39, v95
    v_mul_f32 v108, s39, v96
    v_mul_f32 v109, s39, v97
    v_mul_f32 v110, s39, v98
    v_mul_f32 v111, s39, v99
    v_fmac_f32 v104, s38, v93
    v_fmac_f32 v105, s38, v94
    v_fmac_f32 v106, s38, v95
    v_fmac_f32 v107, s38, v96
    v_fmac_f32 v108, s38, v97
    v_fmac_f32 v109, s38, v98
    v_fmac_f32 v110, s38, v99
    v_fmac_f32 v111, s38, v100
    v_fmac_f32 v104, s37, v94
    v_fmac_f32 v105, s37, v95
    v_fmac_f32 v106, s37, v96
    v_fmac_f32 v107, s37, v97
    v_fmac_f32 v108, s37, v98
    v_fmac_f32 v109, s37, v99
    v_fmac_f32 v110, s37, v100
    v_fmac_f32 v111, s37, v101
    v_fmac_f32 v104, s36, v95
    v_fmac_f32 v105, s36, v96
    v_fmac_f32 v106, s36, v97
    v_fmac_f32 v107, s36, v98
    v_fmac_f32 v108, s36, v99
    v_fmac_f32 v109, s36, v100
    v_fmac_f32 v110, s36, v101
    v_fmac_f32 v111, s36, v102
    v_and_b32 v92, 0xffff0000, v60
    v_and_b32 v93, 0xffff0000, v64
    v_and_b32 v94, 0xffff0000, v68
    v_and_b32 v95, 0xffff0000, v72
    v_and_b32 v96, 0xffff0000, v76
    v_and_b32 v97, 0xffff0000, v80
    v_and_b32 v98, 0xffff0000, v84
    v_and_b32 v99, 0xffff0000, v88
    v_mul_f32 v104, v104, v92
    v_mul_f32 v105, v105, v93
    v_mul_f32 v106, v106, v94
    v_mul_f32 v107, v107, v95
    v_mul_f32 v108, v108, v96
    v_mul_f32 v109, v109, v97
    v_mul_f32 v110, v110, v98
    v_mul_f32 v111, v111, v99
    v_cvt_pk_bf16_f32 v116, v111, v110
    v_cvt_pk_bf16_f32 v117, v109, v108
    v_cvt_pk_bf16_f32 v118, v107, v106
    v_cvt_pk_bf16_f32 v119, v105, v104
    ds_write_b128 v6, v[116:119] offset:7680
    s_lshl_b32 s36, s52, 16
    s_and_b32 s37, s52, 0xffff0000
    s_lshl_b32 s38, s53, 16
    s_and_b32 s39, s53, 0xffff0000
    v_lshlrev_b32 v92, 16, v17
    v_lshlrev_b32 v93, 16, v21
    v_lshlrev_b32 v94, 16, v25
    v_lshlrev_b32 v95, 16, v29
    v_lshlrev_b32 v96, 16, v33
    v_lshlrev_b32 v97, 16, v37
    v_lshlrev_b32 v98, 16, v41
    v_lshlrev_b32 v99, 16, v45
    v_lshlrev_b32 v100, 16, v49
    v_lshlrev_b32 v101, 16, v53
    v_lshlrev_b32 v102, 16, v57
    v_mul_f32 v104, s39, v92
    v_mul_f32 v105, s39, v93
    v_mul_f32 v106, s39, v94
    v_mul_f32 v107, s39, v95
    v_mul_f32 v108, s39, v96
    v_mul_f32 v109, s39, v97
    v_mul_f32 v110, s39, v98
    v_mul_f32 v111, s39, v99
    v_fmac_f32 v104, s38, v93
    v_fmac_f32 v105, s38, v94
    v_fmac_f32 v106, s38, v95
    v_fmac_f32 v107, s38, v96
    v_fmac_f32 v108, s38, v97
    v_fmac_f32 v109, s38, v98
    v_fmac_f32 v110, s38, v99
    v_fmac_f32 v111, s38, v100
    v_fmac_f32 v104, s37, v94
    v_fmac_f32 v105, s37, v95
    v_fmac_f32 v106, s37, v96
    v_fmac_f32 v107, s37, v97
    v_fmac_f32 v108, s37, v98
    v_fmac_f32 v109, s37, v99
    v_fmac_f32 v110, s37, v100
    v_fmac_f32 v111, s37, v101
    v_fmac_f32 v104, s36, v95
    v_fmac_f32 v105, s36, v96
    v_fmac_f32 v106, s36, v97
    v_fmac_f32 v107, s36, v98
    v_fmac_f32 v108, s36, v99
    v_fmac_f32 v109, s36, v100
    v_fmac_f32 v110, s36, v101
    v_fmac_f32 v111, s36, v102
    v_lshlrev_b32 v92, 16, v61
    v_lshlrev_b32 v93, 16, v65
    v_lshlrev_b32 v94, 16, v69
    v_lshlrev_b32 v95, 16, v73
    v_lshlrev_b32 v96, 16, v77
    v_lshlrev_b32 v97, 16, v81
    v_lshlrev_b32 v98, 16, v85
    v_lshlrev_b32 v99, 16, v89
    v_mul_f32 v104, v104, v92
    v_mul_f32 v105, v105, v93
    v_mul_f32 v106, v106, v94
    v_mul_f32 v107, v107, v95
    v_mul_f32 v108, v108, v96
    v_mul_f32 v109, v109, v97
    v_mul_f32 v110, v110, v98
    v_mul_f32 v111, v111, v99
    v_cvt_pk_bf16_f32 v112, v111, v110
    v_cvt_pk_bf16_f32 v113, v109, v108
    v_cvt_pk_bf16_f32 v114, v107, v106
    v_cvt_pk_bf16_f32 v115, v105, v104
    ds_write_b128 v6, v[112:115] offset:15360
    s_lshl_b32 s36, s54, 16
    s_and_b32 s37, s54, 0xffff0000
    s_lshl_b32 s38, s55, 16
    s_and_b32 s39, s55, 0xffff0000
    v_and_b32 v92, 0xffff0000, v17
    v_and_b32 v93, 0xffff0000, v21
    v_and_b32 v94, 0xffff0000, v25
    v_and_b32 v95, 0xffff0000, v29
    v_and_b32 v96, 0xffff0000, v33
    v_and_b32 v97, 0xffff0000, v37
    v_and_b32 v98, 0xffff0000, v41
    v_and_b32 v99, 0xffff0000, v45
    v_and_b32 v100, 0xffff0000, v49
    v_and_b32 v101, 0xffff0000, v53
    v_and_b32 v102, 0xffff0000, v57
    v_mul_f32 v104, s39, v92
    v_mul_f32 v105, s39, v93
    v_mul_f32 v106, s39, v94
    v_mul_f32 v107, s39, v95
    v_mul_f32 v108, s39, v96
    v_mul_f32 v109, s39, v97
    v_mul_f32 v110, s39, v98
    v_mul_f32 v111, s39, v99
    v_fmac_f32 v104, s38, v93
    v_fmac_f32 v105, s38, v94
    v_fmac_f32 v106, s38, v95
    v_fmac_f32 v107, s38, v96
    v_fmac_f32 v108, s38, v97
    v_fmac_f32 v109, s38, v98
    v_fmac_f32 v110, s38, v99
    v_fmac_f32 v111, s38, v100
    v_fmac_f32 v104, s37, v94
    v_fmac_f32 v105, s37, v95
    v_fmac_f32 v106, s37, v96
    v_fmac_f32 v107, s37, v97
    v_fmac_f32 v108, s37, v98
    v_fmac_f32 v109, s37, v99
    v_fmac_f32 v110, s37, v100
    v_fmac_f32 v111, s37, v101
    v_fmac_f32 v104, s36, v95
    v_fmac_f32 v105, s36, v96
    v_fmac_f32 v106, s36, v97
    v_fmac_f32 v107, s36, v98
    v_fmac_f32 v108, s36, v99
    v_fmac_f32 v109, s36, v100
    v_fmac_f32 v110, s36, v101
    v_fmac_f32 v111, s36, v102
    v_and_b32 v92, 0xffff0000, v61
    v_and_b32 v93, 0xffff0000, v65
    v_and_b32 v94, 0xffff0000, v69
    v_and_b32 v95, 0xffff0000, v73
    v_and_b32 v96, 0xffff0000, v77
    v_and_b32 v97, 0xffff0000, v81
    v_and_b32 v98, 0xffff0000, v85
    v_and_b32 v99, 0xffff0000, v89
    v_mul_f32 v104, v104, v92
    v_mul_f32 v105, v105, v93
    v_mul_f32 v106, v106, v94
    v_mul_f32 v107, v107, v95
    v_mul_f32 v108, v108, v96
    v_mul_f32 v109, v109, v97
    v_mul_f32 v110, v110, v98
    v_mul_f32 v111, v111, v99
    v_cvt_pk_bf16_f32 v116, v111, v110
    v_cvt_pk_bf16_f32 v117, v109, v108
    v_cvt_pk_bf16_f32 v118, v107, v106
    v_cvt_pk_bf16_f32 v119, v105, v104
    ds_write_b128 v6, v[116:119] offset:23040
    s_lshl_b32 s36, s56, 16
    s_and_b32 s37, s56, 0xffff0000
    s_lshl_b32 s38, s57, 16
    s_and_b32 s39, s57, 0xffff0000
    v_lshlrev_b32 v92, 16, v18
    v_lshlrev_b32 v93, 16, v22
    v_lshlrev_b32 v94, 16, v26
    v_lshlrev_b32 v95, 16, v30
    v_lshlrev_b32 v96, 16, v34
    v_lshlrev_b32 v97, 16, v38
    v_lshlrev_b32 v98, 16, v42
    v_lshlrev_b32 v99, 16, v46
    v_lshlrev_b32 v100, 16, v50
    v_lshlrev_b32 v101, 16, v54
    v_lshlrev_b32 v102, 16, v58
    v_mul_f32 v104, s39, v92
    v_mul_f32 v105, s39, v93
    v_mul_f32 v106, s39, v94
    v_mul_f32 v107, s39, v95
    v_mul_f32 v108, s39, v96
    v_mul_f32 v109, s39, v97
    v_mul_f32 v110, s39, v98
    v_mul_f32 v111, s39, v99
    v_fmac_f32 v104, s38, v93
    v_fmac_f32 v105, s38, v94
    v_fmac_f32 v106, s38, v95
    v_fmac_f32 v107, s38, v96
    v_fmac_f32 v108, s38, v97
    v_fmac_f32 v109, s38, v98
    v_fmac_f32 v110, s38, v99
    v_fmac_f32 v111, s38, v100
    v_fmac_f32 v104, s37, v94
    v_fmac_f32 v105, s37, v95
    v_fmac_f32 v106, s37, v96
    v_fmac_f32 v107, s37, v97
    v_fmac_f32 v108, s37, v98
    v_fmac_f32 v109, s37, v99
    v_fmac_f32 v110, s37, v100
    v_fmac_f32 v111, s37, v101
    v_fmac_f32 v104, s36, v95
    v_fmac_f32 v105, s36, v96
    v_fmac_f32 v106, s36, v97
    v_fmac_f32 v107, s36, v98
    v_fmac_f32 v108, s36, v99
    v_fmac_f32 v109, s36, v100
    v_fmac_f32 v110, s36, v101
    v_fmac_f32 v111, s36, v102
    v_lshlrev_b32 v92, 16, v62
    v_lshlrev_b32 v93, 16, v66
    v_lshlrev_b32 v94, 16, v70
    v_lshlrev_b32 v95, 16, v74
    v_lshlrev_b32 v96, 16, v78
    v_lshlrev_b32 v97, 16, v82
    v_lshlrev_b32 v98, 16, v86
    v_lshlrev_b32 v99, 16, v90
    v_mul_f32 v104, v104, v92
    v_mul_f32 v105, v105, v93
    v_mul_f32 v106, v106, v94
    v_mul_f32 v107, v107, v95
    v_mul_f32 v108, v108, v96
    v_mul_f32 v109, v109, v97
    v_mul_f32 v110, v110, v98
    v_mul_f32 v111, v111, v99
    v_cvt_pk_bf16_f32 v112, v111, v110
    v_cvt_pk_bf16_f32 v113, v109, v108
    v_cvt_pk_bf16_f32 v114, v107, v106
    v_cvt_pk_bf16_f32 v115, v105, v104
    ds_write_b128 v6, v[112:115] offset:30720
    s_lshl_b32 s36, s58, 16
    s_and_b32 s37, s58, 0xffff0000
    s_lshl_b32 s38, s59, 16
    s_and_b32 s39, s59, 0xffff0000
    v_and_b32 v92, 0xffff0000, v18
    v_and_b32 v93, 0xffff0000, v22
    v_and_b32 v94, 0xffff0000, v26
    v_and_b32 v95, 0xffff0000, v30
    v_and_b32 v96, 0xffff0000, v34
    v_and_b32 v97, 0xffff0000, v38
    v_and_b32 v98, 0xffff0000, v42
    v_and_b32 v99, 0xffff0000, v46
    v_and_b32 v100, 0xffff0000, v50
    v_and_b32 v101, 0xffff0000, v54
    v_and_b32 v102, 0xffff0000, v58
    v_mul_f32 v104, s39, v92
    v_mul_f32 v105, s39, v93
    v_mul_f32 v106, s39, v94
    v_mul_f32 v107, s39, v95
    v_mul_f32 v108, s39, v96
    v_mul_f32 v109, s39, v97
    v_mul_f32 v110, s39, v98
    v_mul_f32 v111, s39, v99
    v_fmac_f32 v104, s38, v93
    v_fmac_f32 v105, s38, v94
    v_fmac_f32 v106, s38, v95
    v_fmac_f32 v107, s38, v96
    v_fmac_f32 v108, s38, v97
    v_fmac_f32 v109, s38, v98
    v_fmac_f32 v110, s38, v99
    v_fmac_f32 v111, s38, v100
    v_fmac_f32 v104, s37, v94
    v_fmac_f32 v105, s37, v95
    v_fmac_f32 v106, s37, v96
    v_fmac_f32 v107, s37, v97
    v_fmac_f32 v108, s37, v98
    v_fmac_f32 v109, s37, v99
    v_fmac_f32 v110, s37, v100
    v_fmac_f32 v111, s37, v101
    v_fmac_f32 v104, s36, v95
    v_fmac_f32 v105, s36, v96
    v_fmac_f32 v106, s36, v97
    v_fmac_f32 v107, s36, v98
    v_fmac_f32 v108, s36, v99
    v_fmac_f32 v109, s36, v100
    v_fmac_f32 v110, s36, v101
    v_fmac_f32 v111, s36, v102
    v_and_b32 v92, 0xffff0000, v62
    v_and_b32 v93, 0xffff0000, v66
    v_and_b32 v94, 0xffff0000, v70
    v_and_b32 v95, 0xffff0000, v74
    v_and_b32 v96, 0xffff0000, v78
    v_and_b32 v97, 0xffff0000, v82
    v_and_b32 v98, 0xffff0000, v86
    v_and_b32 v99, 0xffff0000, v90
    v_mul_f32 v104, v104, v92
    v_mul_f32 v105, v105, v93
    v_mul_f32 v106, v106, v94
    v_mul_f32 v107, v107, v95
    v_mul_f32 v108, v108, v96
    v_mul_f32 v109, v109, v97
    v_mul_f32 v110, v110, v98
    v_mul_f32 v111, v111, v99
    v_cvt_pk_bf16_f32 v116, v111, v110
    v_cvt_pk_bf16_f32 v117, v109, v108
    v_cvt_pk_bf16_f32 v118, v107, v106
    v_cvt_pk_bf16_f32 v119, v105, v104
    ds_write_b128 v6, v[116:119] offset:38400
    s_lshl_b32 s36, s60, 16
    s_and_b32 s37, s60, 0xffff0000
    s_lshl_b32 s38, s61, 16
    s_and_b32 s39, s61, 0xffff0000
    v_lshlrev_b32 v92, 16, v19
    v_lshlrev_b32 v93, 16, v23
    v_lshlrev_b32 v94, 16, v27
    v_lshlrev_b32 v95, 16, v31
    v_lshlrev_b32 v96, 16, v35
    v_lshlrev_b32 v97, 16, v39
    v_lshlrev_b32 v98, 16, v43
    v_lshlrev_b32 v99, 16, v47
    v_lshlrev_b32 v100, 16, v51
    v_lshlrev_b32 v101, 16, v55
    v_lshlrev_b32 v102, 16, v59
    v_mul_f32 v104, s39, v92
    v_mul_f32 v105, s39, v93
    v_mul_f32 v106, s39, v94
    v_mul_f32 v107, s39, v95
    v_mul_f32 v108, s39, v96
    v_mul_f32 v109, s39, v97
    v_mul_f32 v110, s39, v98
    v_mul_f32 v111, s39, v99
    v_fmac_f32 v104, s38, v93
    v_fmac_f32 v105, s38, v94
    v_fmac_f32 v106, s38, v95
    v_fmac_f32 v107, s38, v96
    v_fmac_f32 v108, s38, v97
    v_fmac_f32 v109, s38, v98
    v_fmac_f32 v110, s38, v99
    v_fmac_f32 v111, s38, v100
    v_fmac_f32 v104, s37, v94
    v_fmac_f32 v105, s37, v95
    v_fmac_f32 v106, s37, v96
    v_fmac_f32 v107, s37, v97
    v_fmac_f32 v108, s37, v98
    v_fmac_f32 v109, s37, v99
    v_fmac_f32 v110, s37, v100
    v_fmac_f32 v111, s37, v101
    v_fmac_f32 v104, s36, v95
    v_fmac_f32 v105, s36, v96
    v_fmac_f32 v106, s36, v97
    v_fmac_f32 v107, s36, v98
    v_fmac_f32 v108, s36, v99
    v_fmac_f32 v109, s36, v100
    v_fmac_f32 v110, s36, v101
    v_fmac_f32 v111, s36, v102
    v_lshlrev_b32 v92, 16, v63
    v_lshlrev_b32 v93, 16, v67
    v_lshlrev_b32 v94, 16, v71
    v_lshlrev_b32 v95, 16, v75
    v_lshlrev_b32 v96, 16, v79
    v_lshlrev_b32 v97, 16, v83
    v_lshlrev_b32 v98, 16, v87
    v_lshlrev_b32 v99, 16, v91
    v_mul_f32 v104, v104, v92
    v_mul_f32 v105, v105, v93
    v_mul_f32 v106, v106, v94
    v_mul_f32 v107, v107, v95
    v_mul_f32 v108, v108, v96
    v_mul_f32 v109, v109, v97
    v_mul_f32 v110, v110, v98
    v_mul_f32 v111, v111, v99
    v_cvt_pk_bf16_f32 v112, v111, v110
    v_cvt_pk_bf16_f32 v113, v109, v108
    v_cvt_pk_bf16_f32 v114, v107, v106
    v_cvt_pk_bf16_f32 v115, v105, v104
    ds_write_b128 v6, v[112:115] offset:46080
    s_lshl_b32 s36, s62, 16
    s_and_b32 s37, s62, 0xffff0000
    s_lshl_b32 s38, s63, 16
    s_and_b32 s39, s63, 0xffff0000
    v_and_b32 v92, 0xffff0000, v19
    v_and_b32 v93, 0xffff0000, v23
    v_and_b32 v94, 0xffff0000, v27
    v_and_b32 v95, 0xffff0000, v31
    v_and_b32 v96, 0xffff0000, v35
    v_and_b32 v97, 0xffff0000, v39
    v_and_b32 v98, 0xffff0000, v43
    v_and_b32 v99, 0xffff0000, v47
    v_and_b32 v100, 0xffff0000, v51
    v_and_b32 v101, 0xffff0000, v55
    v_and_b32 v102, 0xffff0000, v59
    v_mul_f32 v104, s39, v92
    v_mul_f32 v105, s39, v93
    v_mul_f32 v106, s39, v94
    v_mul_f32 v107, s39, v95
    v_mul_f32 v108, s39, v96
    v_mul_f32 v109, s39, v97
    v_mul_f32 v110, s39, v98
    v_mul_f32 v111, s39, v99
    v_fmac_f32 v104, s38, v93
    v_fmac_f32 v105, s38, v94
    v_fmac_f32 v106, s38, v95
    v_fmac_f32 v107, s38, v96
    v_fmac_f32 v108, s38, v97
    v_fmac_f32 v109, s38, v98
    v_fmac_f32 v110, s38, v99
    v_fmac_f32 v111, s38, v100
    v_fmac_f32 v104, s37, v94
    v_fmac_f32 v105, s37, v95
    v_fmac_f32 v106, s37, v96
    v_fmac_f32 v107, s37, v97
    v_fmac_f32 v108, s37, v98
    v_fmac_f32 v109, s37, v99
    v_fmac_f32 v110, s37, v100
    v_fmac_f32 v111, s37, v101
    v_fmac_f32 v104, s36, v95
    v_fmac_f32 v105, s36, v96
    v_fmac_f32 v106, s36, v97
    v_fmac_f32 v107, s36, v98
    v_fmac_f32 v108, s36, v99
    v_fmac_f32 v109, s36, v100
    v_fmac_f32 v110, s36, v101
    v_fmac_f32 v111, s36, v102
    v_and_b32 v92, 0xffff0000, v63
    v_and_b32 v93, 0xffff0000, v67
    v_and_b32 v94, 0xffff0000, v71
    v_and_b32 v95, 0xffff0000, v75
    v_and_b32 v96, 0xffff0000, v79
    v_and_b32 v97, 0xffff0000, v83
    v_and_b32 v98, 0xffff0000, v87
    v_and_b32 v99, 0xffff0000, v91
    v_mul_f32 v104, v104, v92
    v_mul_f32 v105, v105, v93
    v_mul_f32 v106, v106, v94
    v_mul_f32 v107, v107, v95
    v_mul_f32 v108, v108, v96
    v_mul_f32 v109, v109, v97
    v_mul_f32 v110, v110, v98
    v_mul_f32 v111, v111, v99
    v_cvt_pk_bf16_f32 v116, v111, v110
    v_cvt_pk_bf16_f32 v117, v109, v108
    v_cvt_pk_bf16_f32 v118, v107, v106
    v_cvt_pk_bf16_f32 v119, v105, v104
    ds_write_b128 v6, v[116:119] offset:53760
    s_mov_b32 s12, s86
    s_and_b32 s13, s87, 0xffff
    s_mov_b32 s14, 0x200000
    s_mov_b32 s15, 0x00020000
    s_mul_i32 s34, s20, 16640
    s_add_u32 s34, s34, 61440
    v_lshlrev_b32 v8, 4, v0
    v_add_u32 v9, s34, v8
    v_lshrrev_b32 v10, 2, v0
    v_mul_u32_u24 v10, 4160, v10
    v_and_b32 v11, 3, v0
    v_lshl_add_u32 v10, v11, 4, v10
    v_add_u32 v10, s34, v10
    v_and_b32 v11, 31, v0
    v_lshrrev_b32 v12, 5, v0
    v_lshlrev_b32 v13, 3, v12
    v_sub_u32 v13, v11, v13
    v_add_u32 v13, 25, v13
    v_and_b32 v14, 3, v13
    v_mul_u32_u24 v14, 4160, v14
    v_and_b32 v13, -4, v13
    v_lshl_add_u32 v13, v13, 1, v14
    s_sub_u32 s28, s34, 32
    v_add_u32 v13, s28, v13
    v_add_u32 v14, 1, v11
    v_mul_u32_u24 v14, 80, v14
    v_lshl_add_u32 v14, v12, 4, v14
    s_mul_i32 s28, s20, 15360
    v_add_u32 v14, s28, v14
    v_lshlrev_b32 v15, 6, v11
    v_lshl_add_u32 v15, v12, 3, v15
    s_lshl_b32 s28, s20, 13
    s_add_u32 s28, s28, 128000
    v_add_u32 v15, s28, v15
    s_lshl_b32 s35, s32, 15
    s_lshl_b32 s28, s20, 13
    s_add_u32 s35, s35, s28
    v_add_u32 v8, s35, v8
    s_mov_b32 s36, 0
    s_waitcnt lgkmcnt(0)
    s_barrier
L_pbch:
    buffer_load_dwordx4 v[16:19], v8, s[12:15], 0 offen offset:0
    buffer_load_dwordx4 v[20:23], v8, s[12:15], 0 offen offset:4
    buffer_load_dwordx4 v[24:27], v8, s[12:15], 0 offen offset:8
    buffer_load_dwordx4 v[28:31], v8, s[12:15], 0 offen offset:1024
    buffer_load_dwordx4 v[32:35], v8, s[12:15], 0 offen offset:1028
    buffer_load_dwordx4 v[36:39], v8, s[12:15], 0 offen offset:1032
    buffer_load_dwordx4 v[40:43], v8, s[12:15], 0 offen offset:2048
    buffer_load_dwordx4 v[44:47], v8, s[12:15], 0 offen offset:2052
    buffer_load_dwordx4 v[48:51], v8, s[12:15], 0 offen offset:2056
    buffer_load_dwordx4 v[52:55], v8, s[12:15], 0 offen offset:3072
    buffer_load_dwordx4 v[56:59], v8, s[12:15], 0 offen offset:3076
    buffer_load_dwordx4 v[60:63], v8, s[12:15], 0 offen offset:3080
    v_mov_b32 v64, 0
    v_mov_b32 v65, 0
    v_mov_b32 v66, 0
    v_mov_b32 v67, 0
    s_mov_b64 exec, 0xffff
    ds_write_b128 v10, v[64:67]
    s_mov_b64 exec, -1
    s_waitcnt vmcnt(9)
    v_alignbit_b32 v68, v20, v16, 16
    v_alignbit_b32 v72, v24, v20, 16
    v_alignbit_b32 v69, v21, v17, 16
    v_alignbit_b32 v73, v25, v21, 16
    v_alignbit_b32 v70, v22, v18, 16
    v_alignbit_b32 v74, v26, v22, 16
    v_alignbit_b32 v71, v23, v19, 16
    v_alignbit_b32 v75, v27, v23, 16
    ds_write_b128 v9, v[16:19] offset:64
    ds_write_b128 v9, v[68:71] offset:4224
    ds_write_b128 v9, v[20:23] offset:8384
    ds_write_b128 v9, v[72:75] offset:12544
    s_mov_b64 exec, 1
    ds_write_b16 v9, v16 offset:4222
    ds_write_b32 v9, v16 offset:8380
    ds_write_b16 v9, v16 offset:12538
    ds_write_b32 v9, v68 offset:12540
    s_mov_b64 exec, -1
    s_waitcnt vmcnt(6)
    v_alignbit_b32 v76, v32, v28, 16
    v_alignbit_b32 v80, v36, v32, 16
    v_alignbit_b32 v77, v33, v29, 16
    v_alignbit_b32 v81, v37, v33, 16
    v_alignbit_b32 v78, v34, v30, 16
    v_alignbit_b32 v82, v38, v34, 16
    v_alignbit_b32 v79, v35, v31, 16
    v_alignbit_b32 v83, v39, v35, 16
    ds_write_b128 v9, v[28:31] offset:1088
    ds_write_b128 v9, v[76:79] offset:5248
    ds_write_b128 v9, v[32:35] offset:9408
    ds_write_b128 v9, v[80:83] offset:13568
    s_waitcnt vmcnt(3)
    v_alignbit_b32 v68, v44, v40, 16
    v_alignbit_b32 v72, v48, v44, 16
    v_alignbit_b32 v69, v45, v41, 16
    v_alignbit_b32 v73, v49, v45, 16
    v_alignbit_b32 v70, v46, v42, 16
    v_alignbit_b32 v74, v50, v46, 16
    v_alignbit_b32 v71, v47, v43, 16
    v_alignbit_b32 v75, v51, v47, 16
    ds_write_b128 v9, v[40:43] offset:2112
    ds_write_b128 v9, v[68:71] offset:6272
    ds_write_b128 v9, v[44:47] offset:10432
    ds_write_b128 v9, v[72:75] offset:14592
    s_waitcnt vmcnt(0)
    v_alignbit_b32 v76, v56, v52, 16
    v_alignbit_b32 v80, v60, v56, 16
    v_alignbit_b32 v77, v57, v53, 16
    v_alignbit_b32 v81, v61, v57, 16
    v_alignbit_b32 v78, v58, v54, 16
    v_alignbit_b32 v82, v62, v58, 16
    v_alignbit_b32 v79, v59, v55, 16
    v_alignbit_b32 v83, v63, v59, 16
    ds_write_b128 v9, v[52:55] offset:3136
    ds_write_b128 v9, v[76:79] offset:7296
    ds_write_b128 v9, v[56:59] offset:11456
    ds_write_b128 v9, v[80:83] offset:15616
    s_waitcnt lgkmcnt(0)
    ds_read_b64 v[16:17], v13 offset:32
    ds_read_b64 v[18:19], v13 offset:40
    ds_read_b64 v[20:21], v13 offset:2080
    ds_read_b64 v[22:23], v13 offset:2088
    ds_read_b128 v[24:27], v14 offset:2480
    ds_read_b128 v[28:31], v14 offset:5040
    ds_read_b64 v[32:33], v13 offset:0
    ds_read_b64 v[34:35], v13 offset:8
    ds_read_b64 v[36:37], v13 offset:2048
    ds_read_b64 v[38:39], v13 offset:2056
    ds_read_b128 v[40:43], v14 offset:2512
    ds_read_b128 v[44:47], v14 offset:5072
    ds_read_b64 v[48:49], v13 offset:96
    ds_read_b64 v[50:51], v13 offset:104
    ds_read_b64 v[52:53], v13 offset:2144
    ds_read_b64 v[54:55], v13 offset:2152
    ds_read_b128 v[56:59], v14 offset:2400
    ds_read_b128 v[60:63], v14 offset:4960
    s_waitcnt lgkmcnt(12)
    v_mfma_f32_32x32x16_bf16 v[112:127], v[16:19], v[28:31], 0
    v_mfma_f32_32x32x16_bf16 v[96:111], v[16:19], v[24:27], 0
    v_mfma_f32_32x32x16_bf16 v[112:127], v[20:23], v[24:27], v[112:127]
    ds_read_b64 v[16:17], v13 offset:64
    ds_read_b64 v[18:19], v13 offset:72
    ds_read_b64 v[20:21], v13 offset:2112
    ds_read_b64 v[22:23], v13 offset:2120
    ds_read_b128 v[24:27], v14 offset:2432
    ds_read_b128 v[28:31], v14 offset:4992
    s_waitcnt lgkmcnt(12)
    v_mfma_f32_32x32x16_bf16 v[112:127], v[32:35], v[44:47], v[112:127]
    v_mfma_f32_32x32x16_bf16 v[96:111], v[32:35], v[40:43], v[96:111]
    v_mfma_f32_32x32x16_bf16 v[112:127], v[36:39], v[40:43], v[112:127]
    ds_read_b64 v[32:33], v13 offset:160
    ds_read_b64 v[34:35], v13 offset:168
    ds_read_b64 v[36:37], v13 offset:2208
    ds_read_b64 v[38:39], v13 offset:2216
    ds_read_b128 v[40:43], v14 offset:2320
    ds_read_b128 v[44:47], v14 offset:4880
    s_waitcnt lgkmcnt(12)
    v_mfma_f32_32x32x16_bf16 v[112:127], v[48:51], v[60:63], v[112:127]
    v_mfma_f32_32x32x16_bf16 v[96:111], v[48:51], v[56:59], v[96:111]
    v_mfma_f32_32x32x16_bf16 v[112:127], v[52:55], v[56:59], v[112:127]
    ds_read_b64 v[48:49], v13 offset:128
    ds_read_b64 v[50:51], v13 offset:136
    ds_read_b64 v[52:53], v13 offset:2176
    ds_read_b64 v[54:55], v13 offset:2184
    ds_read_b128 v[56:59], v14 offset:2352
    ds_read_b128 v[60:63], v14 offset:4912
    s_waitcnt lgkmcnt(12)
    v_mfma_f32_32x32x16_bf16 v[112:127], v[16:19], v[28:31], v[112:127]
    v_mfma_f32_32x32x16_bf16 v[96:111], v[16:19], v[24:27], v[96:111]
    v_mfma_f32_32x32x16_bf16 v[112:127], v[20:23], v[24:27], v[112:127]
    ds_read_b64 v[16:17], v13 offset:224
    ds_read_b64 v[18:19], v13 offset:232
    ds_read_b64 v[20:21], v13 offset:2272
    ds_read_b64 v[22:23], v13 offset:2280
    ds_read_b128 v[24:27], v14 offset:2240
    ds_read_b128 v[28:31], v14 offset:4800
    s_waitcnt lgkmcnt(12)
    v_mfma_f32_32x32x16_bf16 v[112:127], v[32:35], v[44:47], v[112:127]
    v_mfma_f32_32x32x16_bf16 v[96:111], v[32:35], v[40:43], v[96:111]
    v_mfma_f32_32x32x16_bf16 v[112:127], v[36:39], v[40:43], v[112:127]
    ds_read_b64 v[32:33], v13 offset:192
    ds_read_b64 v[34:35], v13 offset:200
    ds_read_b64 v[36:37], v13 offset:2240
    ds_read_b64 v[38:39], v13 offset:2248
    ds_read_b128 v[40:43], v14 offset:2272
    ds_read_b128 v[44:47], v14 offset:4832
    s_waitcnt lgkmcnt(12)
    v_mfma_f32_32x32x16_bf16 v[112:127], v[48:51], v[60:63], v[112:127]
    v_mfma_f32_32x32x16_bf16 v[96:111], v[48:51], v[56:59], v[96:111]
    v_mfma_f32_32x32x16_bf16 v[112:127], v[52:55], v[56:59], v[112:127]
    ds_read_b64 v[48:49], v13 offset:288
    ds_read_b64 v[50:51], v13 offset:296
    ds_read_b64 v[52:53], v13 offset:2336
    ds_read_b64 v[54:55], v13 offset:2344
    ds_read_b128 v[56:59], v14 offset:2160
    ds_read_b128 v[60:63], v14 offset:4720
    s_waitcnt lgkmcnt(12)
    v_mfma_f32_32x32x16_bf16 v[112:127], v[16:19], v[28:31], v[112:127]
    v_mfma_f32_32x32x16_bf16 v[96:111], v[16:19], v[24:27], v[96:111]
    v_mfma_f32_32x32x16_bf16 v[112:127], v[20:23], v[24:27], v[112:127]
    ds_read_b64 v[16:17], v13 offset:256
    ds_read_b64 v[18:19], v13 offset:264
    ds_read_b64 v[20:21], v13 offset:2304
    ds_read_b64 v[22:23], v13 offset:2312
    ds_read_b128 v[24:27], v14 offset:2192
    ds_read_b128 v[28:31], v14 offset:4752
    s_waitcnt lgkmcnt(12)
    v_mfma_f32_32x32x16_bf16 v[112:127], v[32:35], v[44:47], v[112:127]
    v_mfma_f32_32x32x16_bf16 v[96:111], v[32:35], v[40:43], v[96:111]
    v_mfma_f32_32x32x16_bf16 v[112:127], v[36:39], v[40:43], v[112:127]
    ds_read_b64 v[32:33], v13 offset:352
    ds_read_b64 v[34:35], v13 offset:360
    ds_read_b64 v[36:37], v13 offset:2400
    ds_read_b64 v[38:39], v13 offset:2408
    ds_read_b128 v[40:43], v14 offset:2080
    ds_read_b128 v[44:47], v14 offset:4640
    s_waitcnt lgkmcnt(12)
    v_mfma_f32_32x32x16_bf16 v[112:127], v[48:51], v[60:63], v[112:127]
    v_mfma_f32_32x32x16_bf16 v[96:111], v[48:51], v[56:59], v[96:111]
    v_mfma_f32_32x32x16_bf16 v[112:127], v[52:55], v[56:59], v[112:127]
    ds_read_b64 v[48:49], v13 offset:320
    ds_read_b64 v[50:51], v13 offset:328
    ds_read_b64 v[52:53], v13 offset:2368
    ds_read_b64 v[54:55], v13 offset:2376
    ds_read_b128 v[56:59], v14 offset:2112
    ds_read_b128 v[60:63], v14 offset:4672
    s_waitcnt lgkmcnt(12)
    v_mfma_f32_32x32x16_bf16 v[112:127], v[16:19], v[28:31], v[112:127]
    v_mfma_f32_32x32x16_bf16 v[96:111], v[16:19], v[24:27], v[96:111]
    v_mfma_f32_32x32x16_bf16 v[112:127], v[20:23], v[24:27], v[112:127]
    ds_read_b64 v[16:17], v13 offset:416
    ds_read_b64 v[18:19], v13 offset:424
    ds_read_b64 v[20:21], v13 offset:2464
    ds_read_b64 v[22:23], v13 offset:2472
    ds_read_b128 v[24:27], v14 offset:2000
    ds_read_b128 v[28:31], v14 offset:4560
    s_waitcnt lgkmcnt(12)
    v_mfma_f32_32x32x16_bf16 v[112:127], v[32:35], v[44:47], v[112:127]
    v_mfma_f32_32x32x16_bf16 v[96:111], v[32:35], v[40:43], v[96:111]
    v_mfma_f32_32x32x16_bf16 v[112:127], v[36:39], v[40:43], v[112:127]
    ds_read_b64 v[32:33], v13 offset:384
    ds_read_b64 v[34:35], v13 offset:392
    ds_read_b64 v[36:37], v13 offset:2432
    ds_read_b64 v[38:39], v13 offset:2440
    ds_read_b128 v[40:43], v14 offset:2032
    ds_read_b128 v[44:47], v14 offset:4592
    s_waitcnt lgkmcnt(12)
    v_mfma_f32_32x32x16_bf16 v[112:127], v[48:51], v[60:63], v[112:127]
    v_mfma_f32_32x32x16_bf16 v[96:111], v[48:51], v[56:59], v[96:111]
    v_mfma_f32_32x32x16_bf16 v[112:127], v[52:55], v[56:59], v[112:127]
    ds_read_b64 v[48:49], v13 offset:480
    ds_read_b64 v[50:51], v13 offset:488
    ds_read_b64 v[52:53], v13 offset:2528
    ds_read_b64 v[54:55], v13 offset:2536
    ds_read_b128 v[56:59], v14 offset:1920
    ds_read_b128 v[60:63], v14 offset:4480
    s_waitcnt lgkmcnt(12)
    v_mfma_f32_32x32x16_bf16 v[112:127], v[16:19], v[28:31], v[112:127]
    v_mfma_f32_32x32x16_bf16 v[96:111], v[16:19], v[24:27], v[96:111]
    v_mfma_f32_32x32x16_bf16 v[112:127], v[20:23], v[24:27], v[112:127]
    ds_read_b64 v[16:17], v13 offset:448
    ds_read_b64 v[18:19], v13 offset:456
    ds_read_b64 v[20:21], v13 offset:2496
    ds_read_b64 v[22:23], v13 offset:2504
    ds_read_b128 v[24:27], v14 offset:1952
    ds_read_b128 v[28:31], v14 offset:4512
    s_waitcnt lgkmcnt(12)
    v_mfma_f32_32x32x16_bf16 v[112:127], v[32:35], v[44:47], v[112:127]
    v_mfma_f32_32x32x16_bf16 v[96:111], v[32:35], v[40:43], v[96:111]
    v_mfma_f32_32x32x16_bf16 v[112:127], v[36:39], v[40:43], v[112:127]
    ds_read_b64 v[32:33], v13 offset:544
    ds_read_b64 v[34:35], v13 offset:552
    ds_read_b64 v[36:37], v13 offset:2592
    ds_read_b64 v[38:39], v13 offset:2600
    ds_read_b128 v[40:43], v14 offset:1840
    ds_read_b128 v[44:47], v14 offset:4400
    s_waitcnt lgkmcnt(12)
    v_mfma_f32_32x32x16_bf16 v[112:127], v[48:51], v[60:63], v[112:127]
    v_mfma_f32_32x32x16_bf16 v[96:111], v[48:51], v[56:59], v[96:111]
    v_mfma_f32_32x32x16_bf16 v[112:127], v[52:55], v[56:59], v[112:127]
    ds_read_b64 v[48:49], v13 offset:512
    ds_read_b64 v[50:51], v13 offset:520
    ds_read_b64 v[52:53], v13 offset:2560
    ds_read_b64 v[54:55], v13 offset:2568
    ds_read_b128 v[56:59], v14 offset:1872
    ds_read_b128 v[60:63], v14 offset:4432
    s_waitcnt lgkmcnt(12)
    v_mfma_f32_32x32x16_bf16 v[112:127], v[16:19], v[28:31], v[112:127]
    v_mfma_f32_32x32x16_bf16 v[96:111], v[16:19], v[24:27], v[96:111]
    v_mfma_f32_32x32x16_bf16 v[112:127], v[20:23], v[24:27], v[112:127]
    ds_read_b64 v[16:17], v13 offset:608
    ds_read_b64 v[18:19], v13 offset:616
    ds_read_b64 v[20:21], v13 offset:2656
    ds_read_b64 v[22:23], v13 offset:2664
    ds_read_b128 v[24:27], v14 offset:1760
    ds_read_b128 v[28:31], v14 offset:4320
    s_waitcnt lgkmcnt(12)
    v_mfma_f32_32x32x16_bf16 v[112:127], v[32:35], v[44:47], v[112:127]
    v_mfma_f32_32x32x16_bf16 v[96:111], v[32:35], v[40:43], v[96:111]
    v_mfma_f32_32x32x16_bf16 v[112:127], v[36:39], v[40:43], v[112:127]
    ds_read_b64 v[32:33], v13 offset:576
    ds_read_b64 v[34:35], v13 offset:584
    ds_read_b64 v[36:37], v13 offset:2624
    ds_read_b64 v[38:39], v13 offset:2632
    ds_read_b128 v[40:43], v14 offset:1792
    ds_read_b128 v[44:47], v14 offset:4352
    s_waitcnt lgkmcnt(12)
    v_mfma_f32_32x32x16_bf16 v[112:127], v[48:51], v[60:63], v[112:127]
    v_mfma_f32_32x32x16_bf16 v[96:111], v[48:51], v[56:59], v[96:111]
    v_mfma_f32_32x32x16_bf16 v[112:127], v[52:55], v[56:59], v[112:127]
    ds_read_b64 v[48:49], v13 offset:672
    ds_read_b64 v[50:51], v13 offset:680
    ds_read_b64 v[52:53], v13 offset:2720
    ds_read_b64 v[54:55], v13 offset:2728
    ds_read_b128 v[56:59], v14 offset:1680
    ds_read_b128 v[60:63], v14 offset:4240
    s_waitcnt lgkmcnt(12)
    v_mfma_f32_32x32x16_bf16 v[112:127], v[16:19], v[28:31], v[112:127]
    v_mfma_f32_32x32x16_bf16 v[96:111], v[16:19], v[24:27], v[96:111]
    v_mfma_f32_32x32x16_bf16 v[112:127], v[20:23], v[24:27], v[112:127]
    ds_read_b64 v[16:17], v13 offset:640
    ds_read_b64 v[18:19], v13 offset:648
    ds_read_b64 v[20:21], v13 offset:2688
    ds_read_b64 v[22:23], v13 offset:2696
    ds_read_b128 v[24:27], v14 offset:1712
    ds_read_b128 v[28:31], v14 offset:4272
    s_waitcnt lgkmcnt(12)
    v_mfma_f32_32x32x16_bf16 v[112:127], v[32:35], v[44:47], v[112:127]
    v_mfma_f32_32x32x16_bf16 v[96:111], v[32:35], v[40:43], v[96:111]
    v_mfma_f32_32x32x16_bf16 v[112:127], v[36:39], v[40:43], v[112:127]
    ds_read_b64 v[32:33], v13 offset:736
    ds_read_b64 v[34:35], v13 offset:744
    ds_read_b64 v[36:37], v13 offset:2784
    ds_read_b64 v[38:39], v13 offset:2792
    ds_read_b128 v[40:43], v14 offset:1600
    ds_read_b128 v[44:47], v14 offset:4160
    s_waitcnt lgkmcnt(12)
    v_mfma_f32_32x32x16_bf16 v[112:127], v[48:51], v[60:63], v[112:127]
    v_mfma_f32_32x32x16_bf16 v[96:111], v[48:51], v[56:59], v[96:111]
    v_mfma_f32_32x32x16_bf16 v[112:127], v[52:55], v[56:59], v[112:127]
    ds_read_b64 v[48:49], v13 offset:704
    ds_read_b64 v[50:51], v13 offset:712
    ds_read_b64 v[52:53], v13 offset:2752
    ds_read_b64 v[54:55], v13 offset:2760
    ds_read_b128 v[56:59], v14 offset:1632
    ds_read_b128 v[60:63], v14 offset:4192
    s_waitcnt lgkmcnt(12)
    v_mfma_f32_32x32x16_bf16 v[112:127], v[16:19], v[28:31], v[112:127]
    v_mfma_f32_32x32x16_bf16 v[96:111], v[16:19], v[24:27], v[96:111]
    v_mfma_f32_32x32x16_bf16 v[112:127], v[20:23], v[24:27], v[112:127]
    ds_read_b64 v[16:17], v13 offset:800
    ds_read_b64 v[18:19], v13 offset:808
    ds_read_b64 v[20:21], v13 offset:2848
    ds_read_b64 v[22:23], v13 offset:2856
    ds_read_b128 v[24:27], v14 offset:1520
    ds_read_b128 v[28:31], v14 offset:4080
    s_waitcnt lgkmcnt(12)
    v_mfma_f32_32x32x16_bf16 v[112:127], v[32:35], v[44:47], v[112:127]
    v_mfma_f32_32x32x16_bf16 v[96:111], v[32:35], v[40:43], v[96:111]
    v_mfma_f32_32x32x16_bf16 v[112:127], v[36:39], v[40:43], v[112:127]
    ds_read_b64 v[32:33], v13 offset:768
    ds_read_b64 v[34:35], v13 offset:776
    ds_read_b64 v[36:37], v13 offset:2816
    ds_read_b64 v[38:39], v13 offset:2824
    ds_read_b128 v[40:43], v14 offset:1552
    ds_read_b128 v[44:47], v14 offset:4112
    s_waitcnt lgkmcnt(12)
    v_mfma_f32_32x32x16_bf16 v[112:127], v[48:51], v[60:63], v[112:127]
    v_mfma_f32_32x32x16_bf16 v[96:111], v[48:51], v[56:59], v[96:111]
    v_mfma_f32_32x32x16_bf16 v[112:127], v[52:55], v[56:59], v[112:127]
    ds_read_b64 v[48:49], v13 offset:864
    ds_read_b64 v[50:51], v13 offset:872
    ds_read_b64 v[52:53], v13 offset:2912
    ds_read_b64 v[54:55], v13 offset:2920
    ds_read_b128 v[56:59], v14 offset:1440
    ds_read_b128 v[60:63], v14 offset:4000
    s_waitcnt lgkmcnt(12)
    v_mfma_f32_32x32x16_bf16 v[112:127], v[16:19], v[28:31], v[112:127]
    v_mfma_f32_32x32x16_bf16 v[96:111], v[16:19], v[24:27], v[96:111]
    v_mfma_f32_32x32x16_bf16 v[112:127], v[20:23], v[24:27], v[112:127]
    ds_read_b64 v[16:17], v13 offset:832
    ds_read_b64 v[18:19], v13 offset:840
    ds_read_b64 v[20:21], v13 offset:2880
    ds_read_b64 v[22:23], v13 offset:2888
    ds_read_b128 v[24:27], v14 offset:1472
    ds_read_b128 v[28:31], v14 offset:4032
    s_waitcnt lgkmcnt(12)
    v_mfma_f32_32x32x16_bf16 v[112:127], v[32:35], v[44:47], v[112:127]
    v_mfma_f32_32x32x16_bf16 v[96:111], v[32:35], v[40:43], v[96:111]
    v_mfma_f32_32x32x16_bf16 v[112:127], v[36:39], v[40:43], v[112:127]
    ds_read_b64 v[32:33], v13 offset:928
    ds_read_b64 v[34:35], v13 offset:936
    ds_read_b64 v[36:37], v13 offset:2976
    ds_read_b64 v[38:39], v13 offset:2984
    ds_read_b128 v[40:43], v14 offset:1360
    ds_read_b128 v[44:47], v14 offset:3920
    s_waitcnt lgkmcnt(12)
    v_mfma_f32_32x32x16_bf16 v[112:127], v[48:51], v[60:63], v[112:127]
    v_mfma_f32_32x32x16_bf16 v[96:111], v[48:51], v[56:59], v[96:111]
    v_mfma_f32_32x32x16_bf16 v[112:127], v[52:55], v[56:59], v[112:127]
    ds_read_b64 v[48:49], v13 offset:896
    ds_read_b64 v[50:51], v13 offset:904
    ds_read_b64 v[52:53], v13 offset:2944
    ds_read_b64 v[54:55], v13 offset:2952
    ds_read_b128 v[56:59], v14 offset:1392
    ds_read_b128 v[60:63], v14 offset:3952
    s_waitcnt lgkmcnt(12)
    v_mfma_f32_32x32x16_bf16 v[112:127], v[16:19], v[28:31], v[112:127]
    v_mfma_f32_32x32x16_bf16 v[96:111], v[16:19], v[24:27], v[96:111]
    v_mfma_f32_32x32x16_bf16 v[112:127], v[20:23], v[24:27], v[112:127]
    ds_read_b64 v[16:17], v13 offset:992
    ds_read_b64 v[18:19], v13 offset:1000
    ds_read_b64 v[20:21], v13 offset:3040
    ds_read_b64 v[22:23], v13 offset:3048
    ds_read_b128 v[24:27], v14 offset:1280
    ds_read_b128 v[28:31], v14 offset:3840
    s_waitcnt lgkmcnt(12)
    v_mfma_f32_32x32x16_bf16 v[112:127], v[32:35], v[44:47], v[112:127]
    v_mfma_f32_32x32x16_bf16 v[96:111], v[32:35], v[40:43], v[96:111]
    v_mfma_f32_32x32x16_bf16 v[112:127], v[36:39], v[40:43], v[112:127]
    ds_read_b64 v[32:33], v13 offset:960
    ds_read_b64 v[34:35], v13 offset:968
    ds_read_b64 v[36:37], v13 offset:3008
    ds_read_b64 v[38:39], v13 offset:3016
    ds_read_b128 v[40:43], v14 offset:1312
    ds_read_b128 v[44:47], v14 offset:3872
    s_waitcnt lgkmcnt(12)
    v_mfma_f32_32x32x16_bf16 v[112:127], v[48:51], v[60:63], v[112:127]
    v_mfma_f32_32x32x16_bf16 v[96:111], v[48:51], v[56:59], v[96:111]
    v_mfma_f32_32x32x16_bf16 v[112:127], v[52:55], v[56:59], v[112:127]
    ds_read_b64 v[48:49], v13 offset:1056
    ds_read_b64 v[50:51], v13 offset:1064
    ds_read_b64 v[52:53], v13 offset:3104
    ds_read_b64 v[54:55], v13 offset:3112
    ds_read_b128 v[56:59], v14 offset:1200
    ds_read_b128 v[60:63], v14 offset:3760
    s_waitcnt lgkmcnt(12)
    v_mfma_f32_32x32x16_bf16 v[112:127], v[16:19], v[28:31], v[112:127]
    v_mfma_f32_32x32x16_bf16 v[96:111], v[16:19], v[24:27], v[96:111]
    v_mfma_f32_32x32x16_bf16 v[112:127], v[20:23], v[24:27], v[112:127]
    ds_read_b64 v[16:17], v13 offset:1024
    ds_read_b64 v[18:19], v13 offset:1032
    ds_read_b64 v[20:21], v13 offset:3072
    ds_read_b64 v[22:23], v13 offset:3080
    ds_read_b128 v[24:27], v14 offset:1232
    ds_read_b128 v[28:31], v14 offset:3792
    s_waitcnt lgkmcnt(12)
    v_mfma_f32_32x32x16_bf16 v[112:127], v[32:35], v[44:47], v[112:127]
    v_mfma_f32_32x32x16_bf16 v[96:111], v[32:35], v[40:43], v[96:111]
    v_mfma_f32_32x32x16_bf16 v[112:127], v[36:39], v[40:43], v[112:127]
    ds_read_b64 v[32:33], v13 offset:1120
    ds_read_b64 v[34:35], v13 offset:1128
    ds_read_b64 v[36:37], v13 offset:3168
    ds_read_b64 v[38:39], v13 offset:3176
    ds_read_b128 v[40:43], v14 offset:1120
    ds_read_b128 v[44:47], v14 offset:3680
    s_waitcnt lgkmcnt(12)
    v_mfma_f32_32x32x16_bf16 v[112:127], v[48:51], v[60:63], v[112:127]
    v_mfma_f32_32x32x16_bf16 v[96:111], v[48:51], v[56:59], v[96:111]
    v_mfma_f32_32x32x16_bf16 v[112:127], v[52:55], v[56:59], v[112:127]
    ds_read_b64 v[48:49], v13 offset:1088
    ds_read_b64 v[50:51], v13 offset:1096
    ds_read_b64 v[52:53], v13 offset:3136
    ds_read_b64 v[54:55], v13 offset:3144
    ds_read_b128 v[56:59], v14 offset:1152
    ds_read_b128 v[60:63], v14 offset:3712
    s_waitcnt lgkmcnt(12)
    v_mfma_f32_32x32x16_bf16 v[112:127], v[16:19], v[28:31], v[112:127]
    v_mfma_f32_32x32x16_bf16 v[96:111], v[16:19], v[24:27], v[96:111]
    v_mfma_f32_32x32x16_bf16 v[112:127], v[20:23], v[24:27], v[112:127]
    ds_read_b64 v[16:17], v13 offset:1184
    ds_read_b64 v[18:19], v13 offset:1192
    ds_read_b64 v[20:21], v13 offset:3232
    ds_read_b64 v[22:23], v13 offset:3240
    ds_read_b128 v[24:27], v14 offset:1040
    ds_read_b128 v[28:31], v14 offset:3600
    s_waitcnt lgkmcnt(12)
    v_mfma_f32_32x32x16_bf16 v[112:127], v[32:35], v[44:47], v[112:127]
    v_mfma_f32_32x32x16_bf16 v[96:111], v[32:35], v[40:43], v[96:111]
    v_mfma_f32_32x32x16_bf16 v[112:127], v[36:39], v[40:43], v[112:127]
    ds_read_b64 v[32:33], v13 offset:1152
    ds_read_b64 v[34:35], v13 offset:1160
    ds_read_b64 v[36:37], v13 offset:3200
    ds_read_b64 v[38:39], v13 offset:3208
    ds_read_b128 v[40:43], v14 offset:1072
    ds_read_b128 v[44:47], v14 offset:3632
    s_waitcnt lgkmcnt(12)
    v_mfma_f32_32x32x16_bf16 v[112:127], v[48:51], v[60:63], v[112:127]
    v_mfma_f32_32x32x16_bf16 v[96:111], v[48:51], v[56:59], v[96:111]
    v_mfma_f32_32x32x16_bf16 v[112:127], v[52:55], v[56:59], v[112:127]
    ds_read_b64 v[48:49], v13 offset:1248
    ds_read_b64 v[50:51], v13 offset:1256
    ds_read_b64 v[52:53], v13 offset:3296
    ds_read_b64 v[54:55], v13 offset:3304
    ds_read_b128 v[56:59], v14 offset:960
    ds_read_b128 v[60:63], v14 offset:3520
    s_waitcnt lgkmcnt(12)
    v_mfma_f32_32x32x16_bf16 v[112:127], v[16:19], v[28:31], v[112:127]
    v_mfma_f32_32x32x16_bf16 v[96:111], v[16:19], v[24:27], v[96:111]
    v_mfma_f32_32x32x16_bf16 v[112:127], v[20:23], v[24:27], v[112:127]
    ds_read_b64 v[16:17], v13 offset:1216
    ds_read_b64 v[18:19], v13 offset:1224
    ds_read_b64 v[20:21], v13 offset:3264
    ds_read_b64 v[22:23], v13 offset:3272
    ds_read_b128 v[24:27], v14 offset:992
    ds_read_b128 v[28:31], v14 offset:3552
    s_waitcnt lgkmcnt(12)
    v_mfma_f32_32x32x16_bf16 v[112:127], v[32:35], v[44:47], v[112:127]
    v_mfma_f32_32x32x16_bf16 v[96:111], v[32:35], v[40:43], v[96:111]
    v_mfma_f32_32x32x16_bf16 v[112:127], v[36:39], v[40:43], v[112:127]
    ds_read_b64 v[32:33], v13 offset:1312
    ds_read_b64 v[34:35], v13 offset:1320
    ds_read_b64 v[36:37], v13 offset:3360
    ds_read_b64 v[38:39], v13 offset:3368
    ds_read_b128 v[40:43], v14 offset:880
    ds_read_b128 v[44:47], v14 offset:3440
    s_waitcnt lgkmcnt(12)
    v_mfma_f32_32x32x16_bf16 v[112:127], v[48:51], v[60:63], v[112:127]
    v_mfma_f32_32x32x16_bf16 v[96:111], v[48:51], v[56:59], v[96:111]
    v_mfma_f32_32x32x16_bf16 v[112:127], v[52:55], v[56:59], v[112:127]
    ds_read_b64 v[48:49], v13 offset:1280
    ds_read_b64 v[50:51], v13 offset:1288
    ds_read_b64 v[52:53], v13 offset:3328
    ds_read_b64 v[54:55], v13 offset:3336
    ds_read_b128 v[56:59], v14 offset:912
    ds_read_b128 v[60:63], v14 offset:3472
    s_waitcnt lgkmcnt(12)
    v_mfma_f32_32x32x16_bf16 v[112:127], v[16:19], v[28:31], v[112:127]
    v_mfma_f32_32x32x16_bf16 v[96:111], v[16:19], v[24:27], v[96:111]
    v_mfma_f32_32x32x16_bf16 v[112:127], v[20:23], v[24:27], v[112:127]
    ds_read_b64 v[16:17], v13 offset:1376
    ds_read_b64 v[18:19], v13 offset:1384
    ds_read_b64 v[20:21], v13 offset:3424
    ds_read_b64 v[22:23], v13 offset:3432
    ds_read_b128 v[24:27], v14 offset:800
    ds_read_b128 v[28:31], v14 offset:3360
    s_waitcnt lgkmcnt(12)
    v_mfma_f32_32x32x16_bf16 v[112:127], v[32:35], v[44:47], v[112:127]
    v_mfma_f32_32x32x16_bf16 v[96:111], v[32:35], v[40:43], v[96:111]
    v_mfma_f32_32x32x16_bf16 v[112:127], v[36:39], v[40:43], v[112:127]
    ds_read_b64 v[32:33], v13 offset:1344
    ds_read_b64 v[34:35], v13 offset:1352
    ds_read_b64 v[36:37], v13 offset:3392
    ds_read_b64 v[38:39], v13 offset:3400
    ds_read_b128 v[40:43], v14 offset:832
    ds_read_b128 v[44:47], v14 offset:3392
    s_waitcnt lgkmcnt(12)
    v_mfma_f32_32x32x16_bf16 v[112:127], v[48:51], v[60:63], v[112:127]
    v_mfma_f32_32x32x16_bf16 v[96:111], v[48:51], v[56:59], v[96:111]
    v_mfma_f32_32x32x16_bf16 v[112:127], v[52:55], v[56:59], v[112:127]
    ds_read_b64 v[48:49], v13 offset:1440
    ds_read_b64 v[50:51], v13 offset:1448
    ds_read_b64 v[52:53], v13 offset:3488
    ds_read_b64 v[54:55], v13 offset:3496
    ds_read_b128 v[56:59], v14 offset:720
    ds_read_b128 v[60:63], v14 offset:3280
    s_waitcnt lgkmcnt(12)
    v_mfma_f32_32x32x16_bf16 v[112:127], v[16:19], v[28:31], v[112:127]
    v_mfma_f32_32x32x16_bf16 v[96:111], v[16:19], v[24:27], v[96:111]
    v_mfma_f32_32x32x16_bf16 v[112:127], v[20:23], v[24:27], v[112:127]
    ds_read_b64 v[16:17], v13 offset:1408
    ds_read_b64 v[18:19], v13 offset:1416
    ds_read_b64 v[20:21], v13 offset:3456
    ds_read_b64 v[22:23], v13 offset:3464
    ds_read_b128 v[24:27], v14 offset:752
    ds_read_b128 v[28:31], v14 offset:3312
    s_waitcnt lgkmcnt(12)
    v_mfma_f32_32x32x16_bf16 v[112:127], v[32:35], v[44:47], v[112:127]
    v_mfma_f32_32x32x16_bf16 v[96:111], v[32:35], v[40:43], v[96:111]
    v_mfma_f32_32x32x16_bf16 v[112:127], v[36:39], v[40:43], v[112:127]
    ds_read_b64 v[32:33], v13 offset:1504
    ds_read_b64 v[34:35], v13 offset:1512
    ds_read_b64 v[36:37], v13 offset:3552
    ds_read_b64 v[38:39], v13 offset:3560
    ds_read_b128 v[40:43], v14 offset:640
    ds_read_b128 v[44:47], v14 offset:3200
    s_waitcnt lgkmcnt(12)
    v_mfma_f32_32x32x16_bf16 v[112:127], v[48:51], v[60:63], v[112:127]
    v_mfma_f32_32x32x16_bf16 v[96:111], v[48:51], v[56:59], v[96:111]
    v_mfma_f32_32x32x16_bf16 v[112:127], v[52:55], v[56:59], v[112:127]
    ds_read_b64 v[48:49], v13 offset:1472
    ds_read_b64 v[50:51], v13 offset:1480
    ds_read_b64 v[52:53], v13 offset:3520
    ds_read_b64 v[54:55], v13 offset:3528
    ds_read_b128 v[56:59], v14 offset:672
    ds_read_b128 v[60:63], v14 offset:3232
    s_waitcnt lgkmcnt(12)
    v_mfma_f32_32x32x16_bf16 v[112:127], v[16:19], v[28:31], v[112:127]
    v_mfma_f32_32x32x16_bf16 v[96:111], v[16:19], v[24:27], v[96:111]
    v_mfma_f32_32x32x16_bf16 v[112:127], v[20:23], v[24:27], v[112:127]
    ds_read_b64 v[16:17], v13 offset:1568
    ds_read_b64 v[18:19], v13 offset:1576
    ds_read_b64 v[20:21], v13 offset:3616
    ds_read_b64 v[22:23], v13 offset:3624
    ds_read_b128 v[24:27], v14 offset:560
    ds_read_b128 v[28:31], v14 offset:3120
    s_waitcnt lgkmcnt(12)
    v_mfma_f32_32x32x16_bf16 v[112:127], v[32:35], v[44:47], v[112:127]
    v_mfma_f32_32x32x16_bf16 v[96:111], v[32:35], v[40:43], v[96:111]
    v_mfma_f32_32x32x16_bf16 v[112:127], v[36:39], v[40:43], v[112:127]
    ds_read_b64 v[32:33], v13 offset:1536
    ds_read_b64 v[34:35], v13 offset:1544
    ds_read_b64 v[36:37], v13 offset:3584
    ds_read_b64 v[38:39], v13 offset:3592
    ds_read_b128 v[40:43], v14 offset:592
    ds_read_b128 v[44:47], v14 offset:3152
    s_waitcnt lgkmcnt(12)
    v_mfma_f32_32x32x16_bf16 v[112:127], v[48:51], v[60:63], v[112:127]
    v_mfma_f32_32x32x16_bf16 v[96:111], v[48:51], v[56:59], v[96:111]
    v_mfma_f32_32x32x16_bf16 v[112:127], v[52:55], v[56:59], v[112:127]
    ds_read_b64 v[48:49], v13 offset:1632
    ds_read_b64 v[50:51], v13 offset:1640
    ds_read_b64 v[52:53], v13 offset:3680
    ds_read_b64 v[54:55], v13 offset:3688
    ds_read_b128 v[56:59], v14 offset:480
    ds_read_b128 v[60:63], v14 offset:3040
    s_waitcnt lgkmcnt(12)
    v_mfma_f32_32x32x16_bf16 v[112:127], v[16:19], v[28:31], v[112:127]
    v_mfma_f32_32x32x16_bf16 v[96:111], v[16:19], v[24:27], v[96:111]
    v_mfma_f32_32x32x16_bf16 v[112:127], v[20:23], v[24:27], v[112:127]
    ds_read_b64 v[16:17], v13 offset:1600
    ds_read_b64 v[18:19], v13 offset:1608
    ds_read_b64 v[20:21], v13 offset:3648
    ds_read_b64 v[22:23], v13 offset:3656
    ds_read_b128 v[24:27], v14 offset:512
    ds_read_b128 v[28:31], v14 offset:3072
    s_waitcnt lgkmcnt(12)
    v_mfma_f32_32x32x16_bf16 v[112:127], v[32:35], v[44:47], v[112:127]
    v_mfma_f32_32x32x16_bf16 v[96:111], v[32:35], v[40:43], v[96:111]
    v_mfma_f32_32x32x16_bf16 v[112:127], v[36:39], v[40:43], v[112:127]
    ds_read_b64 v[32:33], v13 offset:1696
    ds_read_b64 v[34:35], v13 offset:1704
    ds_read_b64 v[36:37], v13 offset:3744
    ds_read_b64 v[38:39], v13 offset:3752
    ds_read_b128 v[40:43], v14 offset:400
    ds_read_b128 v[44:47], v14 offset:2960
    s_waitcnt lgkmcnt(12)
    v_mfma_f32_32x32x16_bf16 v[112:127], v[48:51], v[60:63], v[112:127]
    v_mfma_f32_32x32x16_bf16 v[96:111], v[48:51], v[56:59], v[96:111]
    v_mfma_f32_32x32x16_bf16 v[112:127], v[52:55], v[56:59], v[112:127]
    ds_read_b64 v[48:49], v13 offset:1664
    ds_read_b64 v[50:51], v13 offset:1672
    ds_read_b64 v[52:53], v13 offset:3712
    ds_read_b64 v[54:55], v13 offset:3720
    ds_read_b128 v[56:59], v14 offset:432
    ds_read_b128 v[60:63], v14 offset:2992
    s_waitcnt lgkmcnt(12)
    v_mfma_f32_32x32x16_bf16 v[112:127], v[16:19], v[28:31], v[112:127]
    v_mfma_f32_32x32x16_bf16 v[96:111], v[16:19], v[24:27], v[96:111]
    v_mfma_f32_32x32x16_bf16 v[112:127], v[20:23], v[24:27], v[112:127]
    ds_read_b64 v[16:17], v13 offset:1760
    ds_read_b64 v[18:19], v13 offset:1768
    ds_read_b64 v[20:21], v13 offset:3808
    ds_read_b64 v[22:23], v13 offset:3816
    ds_read_b128 v[24:27], v14 offset:320
    ds_read_b128 v[28:31], v14 offset:2880
    s_waitcnt lgkmcnt(12)
    v_mfma_f32_32x32x16_bf16 v[112:127], v[32:35], v[44:47], v[112:127]
    v_mfma_f32_32x32x16_bf16 v[96:111], v[32:35], v[40:43], v[96:111]
    v_mfma_f32_32x32x16_bf16 v[112:127], v[36:39], v[40:43], v[112:127]
    ds_read_b64 v[32:33], v13 offset:1728
    ds_read_b64 v[34:35], v13 offset:1736
    ds_read_b64 v[36:37], v13 offset:3776
    ds_read_b64 v[38:39], v13 offset:3784
    ds_read_b128 v[40:43], v14 offset:352
    ds_read_b128 v[44:47], v14 offset:2912
    s_waitcnt lgkmcnt(12)
    v_mfma_f32_32x32x16_bf16 v[112:127], v[48:51], v[60:63], v[112:127]
    v_mfma_f32_32x32x16_bf16 v[96:111], v[48:51], v[56:59], v[96:111]
    v_mfma_f32_32x32x16_bf16 v[112:127], v[52:55], v[56:59], v[112:127]
    ds_read_b64 v[48:49], v13 offset:1824
    ds_read_b64 v[50:51], v13 offset:1832
    ds_read_b64 v[52:53], v13 offset:3872
    ds_read_b64 v[54:55], v13 offset:3880
    ds_read_b128 v[56:59], v14 offset:240
    ds_read_b128 v[60:63], v14 offset:2800
    s_waitcnt lgkmcnt(12)
    v_mfma_f32_32x32x16_bf16 v[112:127], v[16:19], v[28:31], v[112:127]
    v_mfma_f32_32x32x16_bf16 v[96:111], v[16:19], v[24:27], v[96:111]
    v_mfma_f32_32x32x16_bf16 v[112:127], v[20:23], v[24:27], v[112:127]
    ds_read_b64 v[16:17], v13 offset:1792
    ds_read_b64 v[18:19], v13 offset:1800
    ds_read_b64 v[20:21], v13 offset:3840
    ds_read_b64 v[22:23], v13 offset:3848
    ds_read_b128 v[24:27], v14 offset:272
    ds_read_b128 v[28:31], v14 offset:2832
    s_waitcnt lgkmcnt(12)
    v_mfma_f32_32x32x16_bf16 v[112:127], v[32:35], v[44:47], v[112:127]
    v_mfma_f32_32x32x16_bf16 v[96:111], v[32:35], v[40:43], v[96:111]
    v_mfma_f32_32x32x16_bf16 v[112:127], v[36:39], v[40:43], v[112:127]
    ds_read_b64 v[32:33], v13 offset:1888
    ds_read_b64 v[34:35], v13 offset:1896
    ds_read_b64 v[36:37], v13 offset:3936
    ds_read_b64 v[38:39], v13 offset:3944
    ds_read_b128 v[40:43], v14 offset:160
    ds_read_b128 v[44:47], v14 offset:2720
    s_waitcnt lgkmcnt(12)
    v_mfma_f32_32x32x16_bf16 v[112:127], v[48:51], v[60:63], v[112:127]
    v_mfma_f32_32x32x16_bf16 v[96:111], v[48:51], v[56:59], v[96:111]
    v_mfma_f32_32x32x16_bf16 v[112:127], v[52:55], v[56:59], v[112:127]
    ds_read_b64 v[48:49], v13 offset:1856
    ds_read_b64 v[50:51], v13 offset:1864
    ds_read_b64 v[52:53], v13 offset:3904
    ds_read_b64 v[54:55], v13 offset:3912
    ds_read_b128 v[56:59], v14 offset:192
    ds_read_b128 v[60:63], v14 offset:2752
    s_waitcnt lgkmcnt(12)
    v_mfma_f32_32x32x16_bf16 v[112:127], v[16:19], v[28:31], v[112:127]
    v_mfma_f32_32x32x16_bf16 v[96:111], v[16:19], v[24:27], v[96:111]
    v_mfma_f32_32x32x16_bf16 v[112:127], v[20:23], v[24:27], v[112:127]
    ds_read_b64 v[16:17], v13 offset:1952
    ds_read_b64 v[18:19], v13 offset:1960
    ds_read_b64 v[20:21], v13 offset:4000
    ds_read_b64 v[22:23], v13 offset:4008
    ds_read_b128 v[24:27], v14 offset:80
    ds_read_b128 v[28:31], v14 offset:2640
    s_waitcnt lgkmcnt(12)
    v_mfma_f32_32x32x16_bf16 v[112:127], v[32:35], v[44:47], v[112:127]
    v_mfma_f32_32x32x16_bf16 v[96:111], v[32:35], v[40:43], v[96:111]
    v_mfma_f32_32x32x16_bf16 v[112:127], v[36:39], v[40:43], v[112:127]
    ds_read_b64 v[32:33], v13 offset:1920
    ds_read_b64 v[34:35], v13 offset:1928
    ds_read_b64 v[36:37], v13 offset:3968
    ds_read_b64 v[38:39], v13 offset:3976
    ds_read_b128 v[40:43], v14 offset:112
    ds_read_b128 v[44:47], v14 offset:2672
    s_waitcnt lgkmcnt(12)
    v_mfma_f32_32x32x16_bf16 v[112:127], v[48:51], v[60:63], v[112:127]
    v_mfma_f32_32x32x16_bf16 v[96:111], v[48:51], v[56:59], v[96:111]
    v_mfma_f32_32x32x16_bf16 v[112:127], v[52:55], v[56:59], v[112:127]
    ds_read_b64 v[48:49], v13 offset:2016
    ds_read_b64 v[50:51], v13 offset:2024
    ds_read_b64 v[52:53], v13 offset:4064
    ds_read_b64 v[54:55], v13 offset:4072
    ds_read_b128 v[56:59], v14 offset:0
    ds_read_b128 v[60:63], v14 offset:2560
    s_waitcnt lgkmcnt(12)
    v_mfma_f32_32x32x16_bf16 v[112:127], v[16:19], v[28:31], v[112:127]
    v_mfma_f32_32x32x16_bf16 v[96:111], v[16:19], v[24:27], v[96:111]
    v_mfma_f32_32x32x16_bf16 v[112:127], v[20:23], v[24:27], v[112:127]
    ds_read_b64 v[16:17], v13 offset:1984
    ds_read_b64 v[18:19], v13 offset:1992
    ds_read_b64 v[20:21], v13 offset:4032
    ds_read_b64 v[22:23], v13 offset:4040
    ds_read_b128 v[24:27], v14 offset:32
    ds_read_b128 v[28:31], v14 offset:2592
    s_waitcnt lgkmcnt(12)
    v_mfma_f32_32x32x16_bf16 v[112:127], v[32:35], v[44:47], v[112:127]
    v_mfma_f32_32x32x16_bf16 v[96:111], v[32:35], v[40:43], v[96:111]
    v_mfma_f32_32x32x16_bf16 v[112:127], v[36:39], v[40:43], v[112:127]
    s_waitcnt lgkmcnt(6)
    v_mfma_f32_32x32x16_bf16 v[112:127], v[48:51], v[60:63], v[112:127]
    v_mfma_f32_32x32x16_bf16 v[96:111], v[48:51], v[56:59], v[96:111]
    v_mfma_f32_32x32x16_bf16 v[112:127], v[52:55], v[56:59], v[112:127]
    s_waitcnt lgkmcnt(0)
    v_mfma_f32_32x32x16_bf16 v[112:127], v[16:19], v[28:31], v[112:127]
    v_mfma_f32_32x32x16_bf16 v[96:111], v[16:19], v[24:27], v[96:111]
    v_mfma_f32_32x32x16_bf16 v[112:127], v[20:23], v[24:27], v[112:127]
    s_nop 15
    v_cvt_pk_bf16_f32 v96, v96, v97
    v_cvt_pk_bf16_f32 v97, v98, v99
    ds_write_b64 v15, v[96:97] offset:0
    v_cvt_pk_bf16_f32 v100, v100, v101
    v_cvt_pk_bf16_f32 v101, v102, v103
    ds_write_b64 v15, v[100:101] offset:16
    v_cvt_pk_bf16_f32 v104, v104, v105
    v_cvt_pk_bf16_f32 v105, v106, v107
    ds_write_b64 v15, v[104:105] offset:32
    v_cvt_pk_bf16_f32 v108, v108, v109
    v_cvt_pk_bf16_f32 v109, v110, v111
    ds_write_b64 v15, v[108:109] offset:48
    v_cvt_pk_bf16_f32 v112, v112, v113
    v_cvt_pk_bf16_f32 v113, v114, v115
    ds_write_b64 v15, v[112:113] offset:2048
    v_cvt_pk_bf16_f32 v116, v116, v117
    v_cvt_pk_bf16_f32 v117, v118, v119
    ds_write_b64 v15, v[116:117] offset:2064
    v_cvt_pk_bf16_f32 v120, v120, v121
    v_cvt_pk_bf16_f32 v121, v122, v123
    ds_write_b64 v15, v[120:121] offset:2080
    v_cvt_pk_bf16_f32 v124, v124, v125
    v_cvt_pk_bf16_f32 v125, v126, v127
    ds_write_b64 v15, v[124:125] offset:2096
    v_add_u32 v8, 0x1000, v8
    v_add_u32 v14, 7680, v14
    v_add_u32 v15, 0x1000, v15
    s_add_u32 s36, s36, 1
    s_cmp_lt_u32 s36, 2
    s_cbranch_scc1 L_pbch
    s_mov_b32 s12, s78
    s_and_b32 s13, s79, 0xffff
    s_mov_b32 s14, 0x200000
    s_mov_b32 s15, 0x00020000
    s_mov_b32 s16, s90
    s_and_b32 s17, s91, 0xffff
    s_mov_b32 s18, 0x400000
    s_mov_b32 s19, 0x00020000
    buffer_load_dwordx4 v[16:19], v2, s[12:15], 0 offen offset:0
    buffer_load_dwordx4 v[20:23], v2, s[12:15], 0 offen offset:1024
    buffer_load_dwordx4 v[24:27], v2, s[12:15], 0 offen offset:2048
    buffer_load_dwordx4 v[28:31], v2, s[12:15], 0 offen offset:3072
    buffer_load_dwordx4 v[32:35], v3, s[12:15], 0 offen offset:0
    buffer_load_dwordx4 v[36:39], v3, s[12:15], 0 offen offset:1024
    buffer_load_dwordx4 v[40:43], v3, s[12:15], 0 offen offset:2048
    buffer_load_dwordx4 v[44:47], v3, s[12:15], 0 offen offset:3072
    v_add_u32 v5, 128000, v5
    v_lshlrev_b32 v7, 14, v1
    s_add_u32 s28, s33, 1024
    v_add_u32 v7, s28, v7
    s_waitcnt lgkmcnt(0)
    s_barrier
    ds_read_b128 v[48:51], v5 offset:0
    ds_read_b128 v[52:55], v5 offset:4096
    ds_read_b128 v[56:59], v5 offset:8192
    ds_read_b128 v[60:63], v5 offset:12288
    ds_read_b128 v[64:67], v5 offset:16384
    ds_read_b128 v[68:71], v5 offset:20480
    ds_read_b128 v[72:75], v5 offset:24576
    ds_read_b128 v[76:79], v5 offset:28672
    s_waitcnt lgkmcnt(0)
    ds_read_b128 v[80:83], v6 offset:0
    ds_read_b128 v[84:87], v6 offset:7680
    ds_read_b128 v[88:91], v6 offset:15360
    ds_read_b128 v[92:95], v6 offset:23040
    ds_read_b128 v[96:99], v6 offset:30720
    ds_read_b128 v[100:103], v6 offset:38400
    ds_read_b128 v[104:107], v6 offset:46080
    ds_read_b128 v[108:111], v6 offset:53760
    s_waitcnt vmcnt(0) lgkmcnt(0)
    s_lshl_b32 s36, s44, 16
    s_and_b32 s37, s44, 0xffff0000
    v_lshlrev_b32 v112, 16, v48
    v_and_b32 v113, 0xffff0000, v83
    v_lshlrev_b32 v114, 16, v16
    v_fmac_f32 v112, s36, v113
    v_mul_f32 v112, v112, v114
    v_lshlrev_b32 v115, 16, v52
    v_and_b32 v116, 0xffff0000, v87
    v_and_b32 v117, 0xffff0000, v16
    v_fmac_f32 v115, s37, v116
    v_mul_f32 v115, v115, v117
    v_cvt_pk_bf16_f32 v16, v112, v115
    v_and_b32 v112, 0xffff0000, v48
    v_lshlrev_b32 v113, 16, v83
    v_lshlrev_b32 v114, 16, v20
    v_fmac_f32 v112, s36, v113
    v_mul_f32 v112, v112, v114
    v_and_b32 v115, 0xffff0000, v52
    v_lshlrev_b32 v116, 16, v87
    v_and_b32 v117, 0xffff0000, v20
    v_fmac_f32 v115, s37, v116
    v_mul_f32 v115, v115, v117
    v_cvt_pk_bf16_f32 v20, v112, v115
    v_lshlrev_b32 v112, 16, v49
    v_and_b32 v113, 0xffff0000, v82
    v_lshlrev_b32 v114, 16, v24
    v_fmac_f32 v112, s36, v113
    v_mul_f32 v112, v112, v114
    v_lshlrev_b32 v115, 16, v53
    v_and_b32 v116, 0xffff0000, v86
    v_and_b32 v117, 0xffff0000, v24
    v_fmac_f32 v115, s37, v116
    v_mul_f32 v115, v115, v117
    v_cvt_pk_bf16_f32 v24, v112, v115
    v_and_b32 v112, 0xffff0000, v49
    v_lshlrev_b32 v113, 16, v82
    v_lshlrev_b32 v114, 16, v28
    v_fmac_f32 v112, s36, v113
    v_mul_f32 v112, v112, v114
    v_and_b32 v115, 0xffff0000, v53
    v_lshlrev_b32 v116, 16, v86
    v_and_b32 v117, 0xffff0000, v28
    v_fmac_f32 v115, s37, v116
    v_mul_f32 v115, v115, v117
    v_cvt_pk_bf16_f32 v28, v112, v115
    v_lshlrev_b32 v112, 16, v50
    v_and_b32 v113, 0xffff0000, v81
    v_lshlrev_b32 v114, 16, v32
    v_fmac_f32 v112, s36, v113
    v_mul_f32 v112, v112, v114
    v_lshlrev_b32 v115, 16, v54
    v_and_b32 v116, 0xffff0000, v85
    v_and_b32 v117, 0xffff0000, v32
    v_fmac_f32 v115, s37, v116
    v_mul_f32 v115, v115, v117
    v_cvt_pk_bf16_f32 v32, v112, v115
    v_and_b32 v112, 0xffff0000, v50
    v_lshlrev_b32 v113, 16, v81
    v_lshlrev_b32 v114, 16, v36
    v_fmac_f32 v112, s36, v113
    v_mul_f32 v112, v112, v114
    v_and_b32 v115, 0xffff0000, v54
    v_lshlrev_b32 v116, 16, v85
    v_and_b32 v117, 0xffff0000, v36
    v_fmac_f32 v115, s37, v116
    v_mul_f32 v115, v115, v117
    v_cvt_pk_bf16_f32 v36, v112, v115
    v_lshlrev_b32 v112, 16, v51
    v_and_b32 v113, 0xffff0000, v80
    v_lshlrev_b32 v114, 16, v40
    v_fmac_f32 v112, s36, v113
    v_mul_f32 v112, v112, v114
    v_lshlrev_b32 v115, 16, v55
    v_and_b32 v116, 0xffff0000, v84
    v_and_b32 v117, 0xffff0000, v40
    v_fmac_f32 v115, s37, v116
    v_mul_f32 v115, v115, v117
    v_cvt_pk_bf16_f32 v40, v112, v115
    v_and_b32 v112, 0xffff0000, v51
    v_lshlrev_b32 v113, 16, v80
    v_lshlrev_b32 v114, 16, v44
    v_fmac_f32 v112, s36, v113
    v_mul_f32 v112, v112, v114
    v_and_b32 v115, 0xffff0000, v55
    v_lshlrev_b32 v116, 16, v84
    v_and_b32 v117, 0xffff0000, v44
    v_fmac_f32 v115, s37, v116
    v_mul_f32 v115, v115, v117
    v_cvt_pk_bf16_f32 v44, v112, v115
    s_lshl_b32 s36, s45, 16
    s_and_b32 s37, s45, 0xffff0000
    v_lshlrev_b32 v112, 16, v56
    v_and_b32 v113, 0xffff0000, v91
    v_lshlrev_b32 v114, 16, v17
    v_fmac_f32 v112, s36, v113
    v_mul_f32 v112, v112, v114
    v_lshlrev_b32 v115, 16, v60
    v_and_b32 v116, 0xffff0000, v95
    v_and_b32 v117, 0xffff0000, v17
    v_fmac_f32 v115, s37, v116
    v_mul_f32 v115, v115, v117
    v_cvt_pk_bf16_f32 v17, v112, v115
    v_and_b32 v112, 0xffff0000, v56
    v_lshlrev_b32 v113, 16, v91
    v_lshlrev_b32 v114, 16, v21
    v_fmac_f32 v112, s36, v113
    v_mul_f32 v112, v112, v114
    v_and_b32 v115, 0xffff0000, v60
    v_lshlrev_b32 v116, 16, v95
    v_and_b32 v117, 0xffff0000, v21
    v_fmac_f32 v115, s37, v116
    v_mul_f32 v115, v115, v117
    v_cvt_pk_bf16_f32 v21, v112, v115
    v_lshlrev_b32 v112, 16, v57
    v_and_b32 v113, 0xffff0000, v90
    v_lshlrev_b32 v114, 16, v25
    v_fmac_f32 v112, s36, v113
    v_mul_f32 v112, v112, v114
    v_lshlrev_b32 v115, 16, v61
    v_and_b32 v116, 0xffff0000, v94
    v_and_b32 v117, 0xffff0000, v25
    v_fmac_f32 v115, s37, v116
    v_mul_f32 v115, v115, v117
    v_cvt_pk_bf16_f32 v25, v112, v115
    v_and_b32 v112, 0xffff0000, v57
    v_lshlrev_b32 v113, 16, v90
    v_lshlrev_b32 v114, 16, v29
    v_fmac_f32 v112, s36, v113
    v_mul_f32 v112, v112, v114
    v_and_b32 v115, 0xffff0000, v61
    v_lshlrev_b32 v116, 16, v94
    v_and_b32 v117, 0xffff0000, v29
    v_fmac_f32 v115, s37, v116
    v_mul_f32 v115, v115, v117
    v_cvt_pk_bf16_f32 v29, v112, v115
    v_lshlrev_b32 v112, 16, v58
    v_and_b32 v113, 0xffff0000, v89
    v_lshlrev_b32 v114, 16, v33
    v_fmac_f32 v112, s36, v113
    v_mul_f32 v112, v112, v114
    v_lshlrev_b32 v115, 16, v62
    v_and_b32 v116, 0xffff0000, v93
    v_and_b32 v117, 0xffff0000, v33
    v_fmac_f32 v115, s37, v116
    v_mul_f32 v115, v115, v117
    v_cvt_pk_bf16_f32 v33, v112, v115
    v_and_b32 v112, 0xffff0000, v58
    v_lshlrev_b32 v113, 16, v89
    v_lshlrev_b32 v114, 16, v37
    v_fmac_f32 v112, s36, v113
    v_mul_f32 v112, v112, v114
    v_and_b32 v115, 0xffff0000, v62
    v_lshlrev_b32 v116, 16, v93
    v_and_b32 v117, 0xffff0000, v37
    v_fmac_f32 v115, s37, v116
    v_mul_f32 v115, v115, v117
    v_cvt_pk_bf16_f32 v37, v112, v115
    v_lshlrev_b32 v112, 16, v59
    v_and_b32 v113, 0xffff0000, v88
    v_lshlrev_b32 v114, 16, v41
    v_fmac_f32 v112, s36, v113
    v_mul_f32 v112, v112, v114
    v_lshlrev_b32 v115, 16, v63
    v_and_b32 v116, 0xffff0000, v92
    v_and_b32 v117, 0xffff0000, v41
    v_fmac_f32 v115, s37, v116
    v_mul_f32 v115, v115, v117
    v_cvt_pk_bf16_f32 v41, v112, v115
    v_and_b32 v112, 0xffff0000, v59
    v_lshlrev_b32 v113, 16, v88
    v_lshlrev_b32 v114, 16, v45
    v_fmac_f32 v112, s36, v113
    v_mul_f32 v112, v112, v114
    v_and_b32 v115, 0xffff0000, v63
    v_lshlrev_b32 v116, 16, v92
    v_and_b32 v117, 0xffff0000, v45
    v_fmac_f32 v115, s37, v116
    v_mul_f32 v115, v115, v117
    v_cvt_pk_bf16_f32 v45, v112, v115
    s_lshl_b32 s36, s46, 16
    s_and_b32 s37, s46, 0xffff0000
    v_lshlrev_b32 v112, 16, v64
    v_and_b32 v113, 0xffff0000, v99
    v_lshlrev_b32 v114, 16, v18
    v_fmac_f32 v112, s36, v113
    v_mul_f32 v112, v112, v114
    v_lshlrev_b32 v115, 16, v68
    v_and_b32 v116, 0xffff0000, v103
    v_and_b32 v117, 0xffff0000, v18
    v_fmac_f32 v115, s37, v116
    v_mul_f32 v115, v115, v117
    v_cvt_pk_bf16_f32 v18, v112, v115
    v_and_b32 v112, 0xffff0000, v64
    v_lshlrev_b32 v113, 16, v99
    v_lshlrev_b32 v114, 16, v22
    v_fmac_f32 v112, s36, v113
    v_mul_f32 v112, v112, v114
    v_and_b32 v115, 0xffff0000, v68
    v_lshlrev_b32 v116, 16, v103
    v_and_b32 v117, 0xffff0000, v22
    v_fmac_f32 v115, s37, v116
    v_mul_f32 v115, v115, v117
    v_cvt_pk_bf16_f32 v22, v112, v115
    v_lshlrev_b32 v112, 16, v65
    v_and_b32 v113, 0xffff0000, v98
    v_lshlrev_b32 v114, 16, v26
    v_fmac_f32 v112, s36, v113
    v_mul_f32 v112, v112, v114
    v_lshlrev_b32 v115, 16, v69
    v_and_b32 v116, 0xffff0000, v102
    v_and_b32 v117, 0xffff0000, v26
    v_fmac_f32 v115, s37, v116
    v_mul_f32 v115, v115, v117
    v_cvt_pk_bf16_f32 v26, v112, v115
    v_and_b32 v112, 0xffff0000, v65
    v_lshlrev_b32 v113, 16, v98
    v_lshlrev_b32 v114, 16, v30
    v_fmac_f32 v112, s36, v113
    v_mul_f32 v112, v112, v114
    v_and_b32 v115, 0xffff0000, v69
    v_lshlrev_b32 v116, 16, v102
    v_and_b32 v117, 0xffff0000, v30
    v_fmac_f32 v115, s37, v116
    v_mul_f32 v115, v115, v117
    v_cvt_pk_bf16_f32 v30, v112, v115
    v_lshlrev_b32 v112, 16, v66
    v_and_b32 v113, 0xffff0000, v97
    v_lshlrev_b32 v114, 16, v34
    v_fmac_f32 v112, s36, v113
    v_mul_f32 v112, v112, v114
    v_lshlrev_b32 v115, 16, v70
    v_and_b32 v116, 0xffff0000, v101
    v_and_b32 v117, 0xffff0000, v34
    v_fmac_f32 v115, s37, v116
    v_mul_f32 v115, v115, v117
    v_cvt_pk_bf16_f32 v34, v112, v115
    v_and_b32 v112, 0xffff0000, v66
    v_lshlrev_b32 v113, 16, v97
    v_lshlrev_b32 v114, 16, v38
    v_fmac_f32 v112, s36, v113
    v_mul_f32 v112, v112, v114
    v_and_b32 v115, 0xffff0000, v70
    v_lshlrev_b32 v116, 16, v101
    v_and_b32 v117, 0xffff0000, v38
    v_fmac_f32 v115, s37, v116
    v_mul_f32 v115, v115, v117
    v_cvt_pk_bf16_f32 v38, v112, v115
    v_lshlrev_b32 v112, 16, v67
    v_and_b32 v113, 0xffff0000, v96
    v_lshlrev_b32 v114, 16, v42
    v_fmac_f32 v112, s36, v113
    v_mul_f32 v112, v112, v114
    v_lshlrev_b32 v115, 16, v71
    v_and_b32 v116, 0xffff0000, v100
    v_and_b32 v117, 0xffff0000, v42
    v_fmac_f32 v115, s37, v116
    v_mul_f32 v115, v115, v117
    v_cvt_pk_bf16_f32 v42, v112, v115
    v_and_b32 v112, 0xffff0000, v67
    v_lshlrev_b32 v113, 16, v96
    v_lshlrev_b32 v114, 16, v46
    v_fmac_f32 v112, s36, v113
    v_mul_f32 v112, v112, v114
    v_and_b32 v115, 0xffff0000, v71
    v_lshlrev_b32 v116, 16, v100
    v_and_b32 v117, 0xffff0000, v46
    v_fmac_f32 v115, s37, v116
    v_mul_f32 v115, v115, v117
    v_cvt_pk_bf16_f32 v46, v112, v115
    s_lshl_b32 s36, s47, 16
    s_and_b32 s37, s47, 0xffff0000
    v_lshlrev_b32 v112, 16, v72
    v_and_b32 v113, 0xffff0000, v107
    v_lshlrev_b32 v114, 16, v19
    v_fmac_f32 v112, s36, v113
    v_mul_f32 v112, v112, v114
    v_lshlrev_b32 v115, 16, v76
    v_and_b32 v116, 0xffff0000, v111
    v_and_b32 v117, 0xffff0000, v19
    v_fmac_f32 v115, s37, v116
    v_mul_f32 v115, v115, v117
    v_cvt_pk_bf16_f32 v19, v112, v115
    v_and_b32 v112, 0xffff0000, v72
    v_lshlrev_b32 v113, 16, v107
    v_lshlrev_b32 v114, 16, v23
    v_fmac_f32 v112, s36, v113
    v_mul_f32 v112, v112, v114
    v_and_b32 v115, 0xffff0000, v76
    v_lshlrev_b32 v116, 16, v111
    v_and_b32 v117, 0xffff0000, v23
    v_fmac_f32 v115, s37, v116
    v_mul_f32 v115, v115, v117
    v_cvt_pk_bf16_f32 v23, v112, v115
    v_lshlrev_b32 v112, 16, v73
    v_and_b32 v113, 0xffff0000, v106
    v_lshlrev_b32 v114, 16, v27
    v_fmac_f32 v112, s36, v113
    v_mul_f32 v112, v112, v114
    v_lshlrev_b32 v115, 16, v77
    v_and_b32 v116, 0xffff0000, v110
    v_and_b32 v117, 0xffff0000, v27
    v_fmac_f32 v115, s37, v116
    v_mul_f32 v115, v115, v117
    v_cvt_pk_bf16_f32 v27, v112, v115
    v_and_b32 v112, 0xffff0000, v73
    v_lshlrev_b32 v113, 16, v106
    v_lshlrev_b32 v114, 16, v31
    v_fmac_f32 v112, s36, v113
    v_mul_f32 v112, v112, v114
    v_and_b32 v115, 0xffff0000, v77
    v_lshlrev_b32 v116, 16, v110
    v_and_b32 v117, 0xffff0000, v31
    v_fmac_f32 v115, s37, v116
    v_mul_f32 v115, v115, v117
    v_cvt_pk_bf16_f32 v31, v112, v115
    v_lshlrev_b32 v112, 16, v74
    v_and_b32 v113, 0xffff0000, v105
    v_lshlrev_b32 v114, 16, v35
    v_fmac_f32 v112, s36, v113
    v_mul_f32 v112, v112, v114
    v_lshlrev_b32 v115, 16, v78
    v_and_b32 v116, 0xffff0000, v109
    v_and_b32 v117, 0xffff0000, v35
    v_fmac_f32 v115, s37, v116
    v_mul_f32 v115, v115, v117
    v_cvt_pk_bf16_f32 v35, v112, v115
    v_and_b32 v112, 0xffff0000, v74
    v_lshlrev_b32 v113, 16, v105
    v_lshlrev_b32 v114, 16, v39
    v_fmac_f32 v112, s36, v113
    v_mul_f32 v112, v112, v114
    v_and_b32 v115, 0xffff0000, v78
    v_lshlrev_b32 v116, 16, v109
    v_and_b32 v117, 0xffff0000, v39
    v_fmac_f32 v115, s37, v116
    v_mul_f32 v115, v115, v117
    v_cvt_pk_bf16_f32 v39, v112, v115
    v_lshlrev_b32 v112, 16, v75
    v_and_b32 v113, 0xffff0000, v104
    v_lshlrev_b32 v114, 16, v43
    v_fmac_f32 v112, s36, v113
    v_mul_f32 v112, v112, v114
    v_lshlrev_b32 v115, 16, v79
    v_and_b32 v116, 0xffff0000, v108
    v_and_b32 v117, 0xffff0000, v43
    v_fmac_f32 v115, s37, v116
    v_mul_f32 v115, v115, v117
    v_cvt_pk_bf16_f32 v43, v112, v115
    v_and_b32 v112, 0xffff0000, v75
    v_lshlrev_b32 v113, 16, v104
    v_lshlrev_b32 v114, 16, v47
    v_fmac_f32 v112, s36, v113
    v_mul_f32 v112, v112, v114
    v_and_b32 v115, 0xffff0000, v79
    v_lshlrev_b32 v116, 16, v108
    v_and_b32 v117, 0xffff0000, v47
    v_fmac_f32 v115, s37, v116
    v_mul_f32 v115, v115, v117
    v_cvt_pk_bf16_f32 v47, v112, v115
    s_mov_b32 s28, 0
    buffer_store_dwordx4 v[16:19], v7, s[16:19], s28 offen offset:0
    s_mov_b32 s28, 0
    buffer_store_dwordx4 v[20:23], v7, s[16:19], s28 offen offset:2048
    s_mov_b32 s28, 4096
    buffer_store_dwordx4 v[24:27], v7, s[16:19], s28 offen offset:0
    s_mov_b32 s28, 4096
    buffer_store_dwordx4 v[28:31], v7, s[16:19], s28 offen offset:2048
    s_mov_b32 s28, 8192
    buffer_store_dwordx4 v[32:35], v7, s[16:19], s28 offen offset:0
    s_mov_b32 s28, 8192
    buffer_store_dwordx4 v[36:39], v7, s[16:19], s28 offen offset:2048
    s_mov_b32 s28, 12288
    buffer_store_dwordx4 v[40:43], v7, s[16:19], s28 offen offset:0
    s_mov_b32 s28, 12288
    buffer_store_dwordx4 v[44:47], v7, s[16:19], s28 offen offset:2048
L_pbend:
    s_waitcnt vmcnt(0) lgkmcnt(0)
    s_barrier
    v_lshrrev_b32 v44, 4, v0
    v_and_b32 v45, 15, v0
    v_bfe_u32 v46, v0, 2, 2
    v_and_b32 v47, 3, v0
    v_lshlrev_b32 v1, 4, v0
    s_lshl_b32 s28, s24, 17
    s_add_u32 s28, s28, s27
    v_add_u32 v60, s28, v1
    v_lshl_add_u32 v61, v44, 2, v46
    v_lshlrev_b32 v61, 10, v61
    v_lshl_add_u32 v61, v47, 4, v61
    s_lshl_b32 s28, s20, 8
    v_add_u32 v61, s28, v61
    v_add_u32 v62, 0x10000, v61
    s_mov_b32 s16, s74
    s_and_b32 s17, s75, 0xffff
    s_mov_b32 s18, 0x400000
    s_mov_b32 s19, 0x00020000
    s_add_u32 m0, s27, 0x0
    s_mov_b32 s28, 0x0
    buffer_load_dwordx4 v60, s[16:19], s28 offen lds
    s_add_u32 m0, s27, 0x1000
    s_mov_b32 s28, 0x1000
    buffer_load_dwordx4 v60, s[16:19], s28 offen lds
    s_add_u32 m0, s27, 0x2000
    s_mov_b32 s28, 0x2000
    buffer_load_dwordx4 v60, s[16:19], s28 offen lds
    s_add_u32 m0, s27, 0x3000
    s_mov_b32 s28, 0x3000
    buffer_load_dwordx4 v60, s[16:19], s28 offen lds
    s_add_u32 m0, s27, 0x4000
    s_mov_b32 s28, 0x4000
    buffer_load_dwordx4 v60, s[16:19], s28 offen lds
    s_add_u32 m0, s27, 0x5000
    s_mov_b32 s28, 0x5000
    buffer_load_dwordx4 v60, s[16:19], s28 offen lds
    s_add_u32 m0, s27, 0x6000
    s_mov_b32 s28, 0x6000
    buffer_load_dwordx4 v60, s[16:19], s28 offen lds
    s_add_u32 m0, s27, 0x7000
    s_mov_b32 s28, 0x7000
    buffer_load_dwordx4 v60, s[16:19], s28 offen lds
    s_add_u32 m0, s27, 0x8000
    s_mov_b32 s28, 0x8000
    buffer_load_dwordx4 v60, s[16:19], s28 offen lds
    s_add_u32 m0, s27, 0x9000
    s_mov_b32 s28, 0x9000
    buffer_load_dwordx4 v60, s[16:19], s28 offen lds
    s_add_u32 m0, s27, 0xa000
    s_mov_b32 s28, 0xa000
    buffer_load_dwordx4 v60, s[16:19], s28 offen lds
    s_add_u32 m0, s27, 0xb000
    s_mov_b32 s28, 0xb000
    buffer_load_dwordx4 v60, s[16:19], s28 offen lds
    s_add_u32 m0, s27, 0xc000
    s_mov_b32 s28, 0xc000
    buffer_load_dwordx4 v60, s[16:19], s28 offen lds
    s_add_u32 m0, s27, 0xd000
    s_mov_b32 s28, 0xd000
    buffer_load_dwordx4 v60, s[16:19], s28 offen lds
    s_add_u32 m0, s27, 0xe000
    s_mov_b32 s28, 0xe000
    buffer_load_dwordx4 v60, s[16:19], s28 offen lds
    s_add_u32 m0, s27, 0xf000
    s_mov_b32 s28, 0xf000
    buffer_load_dwordx4 v60, s[16:19], s28 offen lds
    s_add_u32 m0, s27, 0x10000
    s_mov_b32 s28, 0x10000
    buffer_load_dwordx4 v60, s[16:19], s28 offen lds
    s_add_u32 m0, s27, 0x11000
    s_mov_b32 s28, 0x11000
    buffer_load_dwordx4 v60, s[16:19], s28 offen lds
    s_add_u32 m0, s27, 0x12000
    s_mov_b32 s28, 0x12000
    buffer_load_dwordx4 v60, s[16:19], s28 offen lds
    s_add_u32 m0, s27, 0x13000
    s_mov_b32 s28, 0x13000
    buffer_load_dwordx4 v60, s[16:19], s28 offen lds
    s_add_u32 m0, s27, 0x14000
    s_mov_b32 s28, 0x14000
    buffer_load_dwordx4 v60, s[16:19], s28 offen lds
    s_add_u32 m0, s27, 0x15000
    s_mov_b32 s28, 0x15000
    buffer_load_dwordx4 v60, s[16:19], s28 offen lds
    s_add_u32 m0, s27, 0x16000
    s_mov_b32 s28, 0x16000
    buffer_load_dwordx4 v60, s[16:19], s28 offen lds
    s_add_u32 m0, s27, 0x17000
    s_mov_b32 s28, 0x17000
    buffer_load_dwordx4 v60, s[16:19], s28 offen lds
    s_add_u32 m0, s27, 0x18000
    s_mov_b32 s28, 0x18000
    buffer_load_dwordx4 v60, s[16:19], s28 offen lds
    s_add_u32 m0, s27, 0x19000
    s_mov_b32 s28, 0x19000
    buffer_load_dwordx4 v60, s[16:19], s28 offen lds
    s_add_u32 m0, s27, 0x1a000
    s_mov_b32 s28, 0x1a000
    buffer_load_dwordx4 v60, s[16:19], s28 offen lds
    s_add_u32 m0, s27, 0x1b000
    s_mov_b32 s28, 0x1b000
    buffer_load_dwordx4 v60, s[16:19], s28 offen lds
    s_add_u32 m0, s27, 0x1c000
    s_mov_b32 s28, 0x1c000
    buffer_load_dwordx4 v60, s[16:19], s28 offen lds
    s_add_u32 m0, s27, 0x1d000
    s_mov_b32 s28, 0x1d000
    buffer_load_dwordx4 v60, s[16:19], s28 offen lds
    s_add_u32 m0, s27, 0x1e000
    s_mov_b32 s28, 0x1e000
    buffer_load_dwordx4 v60, s[16:19], s28 offen lds
    s_add_u32 m0, s27, 0x1f000
    s_mov_b32 s28, 0x1f000
    buffer_load_dwordx4 v60, s[16:19], s28 offen lds
    s_waitcnt vmcnt(16)
    s_barrier
    ds_read_b64_tr_b16 v[128:129], v61 offset:0
    ds_read_b64_tr_b16 v[130:131], v61 offset:16384
    ds_read_b64_tr_b16 v[132:133], v61 offset:32768
    ds_read_b64_tr_b16 v[134:135], v61 offset:49152
    ds_read_b64_tr_b16 v[144:145], v61 offset:8
    ds_read_b64_tr_b16 v[146:147], v61 offset:16392
    ds_read_b64_tr_b16 v[148:149], v61 offset:32776
    ds_read_b64_tr_b16 v[150:151], v61 offset:49160
    ds_read_b64_tr_b16 v[160:161], v61 offset:64
    ds_read_b64_tr_b16 v[162:163], v61 offset:16448
    ds_read_b64_tr_b16 v[164:165], v61 offset:32832
    ds_read_b64_tr_b16 v[166:167], v61 offset:49216
    ds_read_b64_tr_b16 v[176:177], v61 offset:72
    ds_read_b64_tr_b16 v[178:179], v61 offset:16456
    ds_read_b64_tr_b16 v[180:181], v61 offset:32840
    ds_read_b64_tr_b16 v[182:183], v61 offset:49224
    ds_read_b64_tr_b16 v[192:193], v61 offset:128
    ds_read_b64_tr_b16 v[194:195], v61 offset:16512
    ds_read_b64_tr_b16 v[196:197], v61 offset:32896
    ds_read_b64_tr_b16 v[198:199], v61 offset:49280
    ds_read_b64_tr_b16 v[208:209], v61 offset:136
    ds_read_b64_tr_b16 v[210:211], v61 offset:16520
    ds_read_b64_tr_b16 v[212:213], v61 offset:32904
    ds_read_b64_tr_b16 v[214:215], v61 offset:49288
    ds_read_b64_tr_b16 v[224:225], v61 offset:192
    ds_read_b64_tr_b16 v[226:227], v61 offset:16576
    ds_read_b64_tr_b16 v[228:229], v61 offset:32960
    ds_read_b64_tr_b16 v[230:231], v61 offset:49344
    ds_read_b64_tr_b16 v[240:241], v61 offset:200
    ds_read_b64_tr_b16 v[242:243], v61 offset:16584
    ds_read_b64_tr_b16 v[244:245], v61 offset:32968
    ds_read_b64_tr_b16 v[246:247], v61 offset:49352
    s_waitcnt lgkmcnt(0)
    s_barrier
    s_waitcnt vmcnt(0)
    s_barrier
    ds_read_b64_tr_b16 v[136:137], v62 offset:0
    ds_read_b64_tr_b16 v[138:139], v62 offset:16384
    ds_read_b64_tr_b16 v[140:141], v62 offset:32768
    ds_read_b64_tr_b16 v[142:143], v62 offset:49152
    ds_read_b64_tr_b16 v[152:153], v62 offset:8
    ds_read_b64_tr_b16 v[154:155], v62 offset:16392
    ds_read_b64_tr_b16 v[156:157], v62 offset:32776
    ds_read_b64_tr_b16 v[158:159], v62 offset:49160
    ds_read_b64_tr_b16 v[168:169], v62 offset:64
    ds_read_b64_tr_b16 v[170:171], v62 offset:16448
    ds_read_b64_tr_b16 v[172:173], v62 offset:32832
    ds_read_b64_tr_b16 v[174:175], v62 offset:49216
    ds_read_b64_tr_b16 v[184:185], v62 offset:72
    ds_read_b64_tr_b16 v[186:187], v62 offset:16456
    ds_read_b64_tr_b16 v[188:189], v62 offset:32840
    ds_read_b64_tr_b16 v[190:191], v62 offset:49224
    ds_read_b64_tr_b16 v[200:201], v62 offset:128
    ds_read_b64_tr_b16 v[202:203], v62 offset:16512
    ds_read_b64_tr_b16 v[204:205], v62 offset:32896
    ds_read_b64_tr_b16 v[206:207], v62 offset:49280
    ds_read_b64_tr_b16 v[216:217], v62 offset:136
    ds_read_b64_tr_b16 v[218:219], v62 offset:16520
    ds_read_b64_tr_b16 v[220:221], v62 offset:32904
    ds_read_b64_tr_b16 v[222:223], v62 offset:49288
    ds_read_b64_tr_b16 v[232:233], v62 offset:192
    ds_read_b64_tr_b16 v[234:235], v62 offset:16576
    ds_read_b64_tr_b16 v[236:237], v62 offset:32960
    ds_read_b64_tr_b16 v[238:239], v62 offset:49344
    ds_read_b64_tr_b16 v[248:249], v62 offset:200
    ds_read_b64_tr_b16 v[250:251], v62 offset:16584
    ds_read_b64_tr_b16 v[252:253], v62 offset:32968
    ds_read_b64_tr_b16 v[254:255], v62 offset:49352
    s_waitcnt lgkmcnt(0)
    s_barrier
    s_mov_b32 s12, s90
    s_and_b32 s13, s91, 0xffff
    s_mov_b32 s14, 0x400000
    s_mov_b32 s15, 0x00020000
    s_and_b32 s36, s20, 1
    s_lshr_b32 s37, s20, 1
    s_lshl_b32 s28, s36, 12
    s_add_u32 s28, s28, 0x4000
    v_add_u32 v2, s28, v1
    s_lshl_b32 s28, s37, 12
    s_add_u32 s28, s28, 0x2000
    v_add_u32 v3, s28, v1
    s_lshl_b32 s28, s20, 12
    v_add_u32 v4, s28, v1
    v_lshrrev_b32 v5, 1, v4
    v_and_b32 v48, 7, v0
    v_lshlrev_b32 v48, 4, v48
    v_lshl_add_u32 v6, v44, 7, v48
    s_add_u32 s28, s27, 0x2000
    v_add_u32 v7, s28, v1
    v_lshlrev_b32 v48, 3, v0
    s_add_u32 s28, s27, 0x3000
    v_add_u32 v8, s28, v48
    s_lshl_b32 s28, s37, 11
    s_add_u32 s28, s28, 0x3000
    v_add_u32 v9, s28, v48
    s_lshl_b32 s28, s36, 12
    s_lshl_b32 s29, s37, 11
    s_add_u32 s28, s28, s29
    s_add_u32 s28, s28, 0x4000
    v_add_u32 v10, s28, v1
    v_lshl_add_u32 v48, v45, 2, v44
    s_lshl_b32 s28, s20, 18
    s_lshl_b32 s29, s24, 10
    s_add_u32 s28, s28, s29
    v_lshl_add_u32 v11, v48, 4, s28
    v_lshlrev_b32 v48, 10, v44
    v_lshl_add_u32 v48, v45, 4, v48
    s_lshl_b32 s28, s24, 15
    s_lshl_b32 s29, s20, 8
    s_add_u32 s28, s28, s29
    v_add_u32 v12, s28, v48
    v_lshlrev_b32 v48, 11, v46
    v_lshl_add_u32 v48, v47, 4, v48
    v_lshl_add_u32 v48, v44, 3, v48
    s_and_b32 s28, s24, 1
    s_lshl_b32 s28, s28, 15
    s_lshr_b32 s29, s24, 1
    s_lshl_b32 s29, s29, 6
    s_add_u32 s28, s28, s29
    s_lshl_b32 s29, s20, 13
    s_add_u32 s28, s28, s29
    v_add_u32 v13, s28, v48
    v_and_b32 v51, 1, v45
    v_lshlrev_b32 v51, 4, v51
    v_mov_b32 v52, 0x3f80
    v_lshlrev_b32 v51, v51, v52
    v_lshrrev_b32 v52, 1, v45
    v_mov_b32 v53, 0xff000000
    s_lshl_b32 s28, s36, 4
    v_add_u32 v54, s28, v45
    v_lshlrev_b32 v55, 2, v44
    s_mov_b32 s35, 0x3e0293ee
    s_mov_b32 s33, s25
    v_cmp_eq_u32 vcc, 0, v52
    v_mov_b32 v32, 0x3f803f80
    v_add_u32 v56, 0, v55
    v_cndmask_b32 v28, 0, v51, vcc
    v_cmp_gt_u32 vcc, v56, v54
    v_add_u32 v56, 16, v56
    s_nop 0
    v_cndmask_b32 v16, 0, v53, vcc
    v_cmp_gt_u32 vcc, v56, v54
    s_nop 1
    v_cndmask_b32 v20, 0, v53, vcc
    v_cmp_lt_u32 vcc, 1, v44
    s_nop 1
    v_cndmask_b32 v24, 0, v53, vcc
    v_cmp_eq_u32 vcc, 1, v52
    v_mov_b32 v33, 0x3f803f80
    v_add_u32 v56, 1, v55
    v_cndmask_b32 v29, 0, v51, vcc
    v_cmp_gt_u32 vcc, v56, v54
    v_add_u32 v56, 16, v56
    s_nop 0
    v_cndmask_b32 v17, 0, v53, vcc
    v_cmp_gt_u32 vcc, v56, v54
    s_nop 1
    v_cndmask_b32 v21, 0, v53, vcc
    v_cmp_lt_u32 vcc, 1, v44
    s_nop 1
    v_cndmask_b32 v25, 0, v53, vcc
    v_cmp_eq_u32 vcc, 2, v52
    v_mov_b32 v34, 0x3f803f80
    v_add_u32 v56, 2, v55
    v_cndmask_b32 v30, 0, v51, vcc
    v_cmp_gt_u32 vcc, v56, v54
    v_add_u32 v56, 16, v56
    s_nop 0
    v_cndmask_b32 v18, 0, v53, vcc
    v_cmp_gt_u32 vcc, v56, v54
    s_nop 1
    v_cndmask_b32 v22, 0, v53, vcc
    v_cmp_lt_u32 vcc, 1, v44
    s_nop 1
    v_cndmask_b32 v26, 0, v53, vcc
    v_cmp_eq_u32 vcc, 3, v52
    v_mov_b32 v35, 0x3f803f80
    v_add_u32 v56, 3, v55
    v_cndmask_b32 v31, 0, v51, vcc
    v_cmp_gt_u32 vcc, v56, v54
    v_add_u32 v56, 16, v56
    s_nop 0
    v_cndmask_b32 v19, 0, v53, vcc
    v_cmp_gt_u32 vcc, v56, v54
    s_nop 1
    v_cndmask_b32 v23, 0, v53, vcc
    v_cmp_lt_u32 vcc, 1, v44
    s_nop 1
    v_cndmask_b32 v27, 0, v53, vcc
L_w3loop:
    s_lshl_b32 s28, s24, 6
    s_add_u32 s28, s28, s33
    s_mul_i32 s34, s28, 24576
    s_add_u32 s34, s34, 0x200000
    s_add_u32 s29, s34, 0x1000
    buffer_load_dwordx4 v[36:39], v2, s[4:7], s34 offen offset:0
    buffer_load_dwordx4 v[40:43], v2, s[4:7], s34 offen offset:1024
    buffer_load_dwordx4 v[44:47], v2, s[4:7], s34 offen offset:2048
    buffer_load_dwordx4 v[48:51], v2, s[4:7], s34 offen offset:3072
    buffer_load_dwordx4 v[80:83], v1, s[4:7], s34 offen offset:0
    buffer_load_dwordx4 v[84:87], v1, s[4:7], s34 offen offset:1024
    buffer_load_dwordx4 v[88:91], v1, s[4:7], s34 offen offset:2048
    buffer_load_dwordx4 v[92:95], v1, s[4:7], s34 offen offset:3072
    buffer_load_dwordx4 v[96:99], v1, s[4:7], s29 offen offset:0
    buffer_load_dwordx4 v[100:103], v1, s[4:7], s29 offen offset:1024
    buffer_load_dwordx4 v[104:107], v1, s[4:7], s29 offen offset:2048
    buffer_load_dwordx4 v[108:111], v1, s[4:7], s29 offen offset:3072
    buffer_load_dwordx4 v[64:67], v3, s[4:7], s34 offen offset:0
    buffer_load_dwordx4 v[68:71], v3, s[4:7], s34 offen offset:1024
    buffer_load_dwordx4 v[72:75], v3, s[4:7], s34 offen offset:2048
    buffer_load_dwordx4 v[76:79], v3, s[4:7], s34 offen offset:3072
    s_waitcnt vmcnt(4)
    v_mfma_f32_16x16x32_bf16 v[52:55], v[80:83], v[36:39], v[16:19]
    v_mfma_f32_16x16x32_bf16 v[56:59], v[96:99], v[36:39], v[20:23]
    v_mfma_f32_16x16x32_bf16 v[52:55], v[84:87], v[40:43], v[52:55]
    v_mfma_f32_16x16x32_bf16 v[56:59], v[100:103], v[40:43], v[56:59]
    v_mfma_f32_16x16x32_bf16 v[52:55], v[88:91], v[44:47], v[52:55]
    v_mfma_f32_16x16x32_bf16 v[56:59], v[104:107], v[44:47], v[56:59]
    v_mfma_f32_16x16x32_bf16 v[52:55], v[92:95], v[48:51], v[52:55]
    v_mfma_f32_16x16x32_bf16 v[56:59], v[108:111], v[48:51], v[56:59]
    s_lshl_b32 s38, s33, 20
    s_add_u32 s38, s38, 0x4000000
    v_mov_b32 v112, 0
    v_mov_b32 v113, 0
    v_mov_b32 v114, 0
    v_mov_b32 v115, 0
    s_add_u32 s28, s38, 0x0
    buffer_store_dwordx4 v[112:115], v11, s[4:7], s28 offen sc0 sc1
    s_add_u32 s28, s38, 0x8000
    buffer_store_dwordx4 v[112:115], v11, s[4:7], s28 offen sc0 sc1
    s_add_u32 s28, s38, 0x10000
    buffer_store_dwordx4 v[112:115], v11, s[4:7], s28 offen sc0 sc1
    s_add_u32 s28, s38, 0x18000
    buffer_store_dwordx4 v[112:115], v11, s[4:7], s28 offen sc0 sc1
    s_add_u32 s28, s38, 0x20000
    buffer_store_dwordx4 v[112:115], v11, s[4:7], s28 offen sc0 sc1
    s_add_u32 s28, s38, 0x28000
    buffer_store_dwordx4 v[112:115], v11, s[4:7], s28 offen sc0 sc1
    s_add_u32 s28, s38, 0x30000
    buffer_store_dwordx4 v[112:115], v11, s[4:7], s28 offen sc0 sc1
    s_add_u32 s28, s38, 0x38000
    buffer_store_dwordx4 v[112:115], v11, s[4:7], s28 offen sc0 sc1
    s_lshl_b32 s39, s33, 7
    s_add_u32 s39, s39, 0x60000
    s_waitcnt vmcnt(0)
    s_barrier
    s_cmp_lg_u32 s20, 0
    s_cbranch_scc1 L_w3nf
    s_lshl_b32 s28, s24, 2
    v_mov_b32 v14, s28
    v_mov_b32 v15, s23
    s_mov_b64 exec, 1
    buffer_store_dword v15, v14, s[4:7], s39 offen sc0 sc1
    s_mov_b64 exec, -1
L_w3nf:
    s_lshl_b32 s38, s33, 14
    s_add_u32 s38, s38, 0x100000
    s_mov_b32 s47, 0
    s_sub_u32 s28, s38, 0x4000
    s_cmp_eq_u32 s33, 0
    s_cbranch_scc1 L_w3m1
L_w3c:
    buffer_load_dword v15, v4, s[4:7], s28 offen offset:8 sc0 sc1
    s_add_u32 s47, s47, 1
    s_cmp_gt_u32 s47, 200000
    s_cbranch_scc1 L_end
    s_waitcnt vmcnt(0)
    v_cmp_ne_u32 vcc, s23, v15
    s_nop 0
    s_cbranch_vccz L_w3m1
    s_sleep 12
    s_branch L_w3c
L_w3m:
    s_sleep 1
L_w3m1:
    buffer_load_dwordx4 v[112:115], v4, s[4:7], s38 offen offset:0 sc0 sc1
    buffer_load_dwordx4 v[116:119], v4, s[4:7], s38 offen offset:1024 sc0 sc1
    buffer_load_dwordx4 v[120:123], v4, s[4:7], s38 offen offset:2048 sc0 sc1
    buffer_load_dwordx4 v[124:127], v4, s[4:7], s38 offen offset:3072 sc0 sc1
    s_add_u32 s47, s47, 1
    s_cmp_gt_u32 s47, 200000
    s_cbranch_scc1 L_end
    v_mov_b32 v14, s23
    s_waitcnt vmcnt(0)
    v_bitop3_b32 v15, v114, v118, v14 bitop3:0x7e
    v_bitop3_b32 v14, v122, v126, v14 bitop3:0x7e
    v_or_b32 v15, v15, v14
    v_cmp_ne_u32 vcc, 0, v15
    s_nop 0
    s_cbranch_vccnz L_w3m
    v_and_b32 v14, 31, v0
    v_lshlrev_b32 v14, 2, v14
    buffer_load_dword v15, v14, s[4:7], s39 offen sc0 sc1
    ds_write_b64 v5, v[112:113] offset:0
    ds_write_b64 v5, v[116:117] offset:512
    ds_write_b64 v5, v[120:121] offset:1024
    ds_write_b64 v5, v[124:125] offset:1536
    s_waitcnt lgkmcnt(0)
    s_barrier
    ds_read_b128 v[80:83], v6 offset:0
    ds_read_b128 v[84:87], v6 offset:512
    ds_read_b128 v[88:91], v6 offset:1024
    ds_read_b128 v[92:95], v6 offset:1536
    ds_read_b128 v[96:99], v6 offset:2048
    ds_read_b128 v[100:103], v6 offset:2560
    ds_read_b128 v[104:107], v6 offset:3072
    ds_read_b128 v[108:111], v6 offset:3584
    s_waitcnt lgkmcnt(7)
    v_mfma_f32_16x16x32_bf16 v[112:115], a[0:3], v[80:83], 0
    v_mfma_f32_16x16x32_bf16 v[120:123], v[80:83], a[128:131], 0
    v_mfma_f32_16x16x32_bf16 v[116:119], a[64:67], v[80:83], 0
    v_mfma_f32_16x16x32_bf16 v[124:127], v[80:83], a[192:195], 0
    ds_read_b128 v[80:83], v6 offset:4096
    s_waitcnt lgkmcnt(7)
    v_mfma_f32_16x16x32_bf16 v[112:115], a[4:7], v[84:87], v[112:115]
    v_mfma_f32_16x16x32_bf16 v[120:123], v[84:87], a[132:135], v[120:123]
    v_mfma_f32_16x16x32_bf16 v[116:119], a[68:71], v[84:87], v[116:119]
    v_mfma_f32_16x16x32_bf16 v[124:127], v[84:87], a[196:199], v[124:127]
    ds_read_b128 v[84:87], v6 offset:4608
    s_waitcnt lgkmcnt(7)
    v_mfma_f32_16x16x32_bf16 v[112:115], a[8:11], v[88:91], v[112:115]
    v_mfma_f32_16x16x32_bf16 v[120:123], v[88:91], a[136:139], v[120:123]
    v_mfma_f32_16x16x32_bf16 v[116:119], a[72:75], v[88:91], v[116:119]
    v_mfma_f32_16x16x32_bf16 v[124:127], v[88:91], a[200:203], v[124:127]
    ds_read_b128 v[88:91], v6 offset:5120
    s_waitcnt lgkmcnt(7)
    v_mfma_f32_16x16x32_bf16 v[112:115], a[12:15], v[92:95], v[112:115]
    v_mfma_f32_16x16x32_bf16 v[120:123], v[92:95], a[140:143], v[120:123]
    v_mfma_f32_16x16x32_bf16 v[116:119], a[76:79], v[92:95], v[116:119]
    v_mfma_f32_16x16x32_bf16 v[124:127], v[92:95], a[204:207], v[124:127]
    ds_read_b128 v[92:95], v6 offset:5632
    s_waitcnt lgkmcnt(7)
    v_mfma_f32_16x16x32_bf16 v[112:115], a[16:19], v[96:99], v[112:115]
    v_mfma_f32_16x16x32_bf16 v[120:123], v[96:99], a[144:147], v[120:123]
    v_mfma_f32_16x16x32_bf16 v[116:119], a[80:83], v[96:99], v[116:119]
    v_mfma_f32_16x16x32_bf16 v[124:127], v[96:99], a[208:211], v[124:127]
    ds_read_b128 v[96:99], v6 offset:6144
    s_waitcnt lgkmcnt(7)
    v_mfma_f32_16x16x32_bf16 v[112:115], a[20:23], v[100:103], v[112:115]
    v_mfma_f32_16x16x32_bf16 v[120:123], v[100:103], a[148:151], v[120:123]
    v_mfma_f32_16x16x32_bf16 v[116:119], a[84:87], v[100:103], v[116:119]
    v_mfma_f32_16x16x32_bf16 v[124:127], v[100:103], a[212:215], v[124:127]
    ds_read_b128 v[100:103], v6 offset:6656
    s_waitcnt lgkmcnt(7)
    v_mfma_f32_16x16x32_bf16 v[112:115], a[24:27], v[104:107], v[112:115]
    v_mfma_f32_16x16x32_bf16 v[120:123], v[104:107], a[152:155], v[120:123]
    v_mfma_f32_16x16x32_bf16 v[116:119], a[88:91], v[104:107], v[116:119]
    v_mfma_f32_16x16x32_bf16 v[124:127], v[104:107], a[216:219], v[124:127]
    ds_read_b128 v[104:107], v6 offset:7168
    s_waitcnt lgkmcnt(7)
    v_mfma_f32_16x16x32_bf16 v[112:115], a[28:31], v[108:111], v[112:115]
    v_mfma_f32_16x16x32_bf16 v[120:123], v[108:111], a[156:159], v[120:123]
    v_mfma_f32_16x16x32_bf16 v[116:119], a[92:95], v[108:111], v[116:119]
    v_mfma_f32_16x16x32_bf16 v[124:127], v[108:111], a[220:223], v[124:127]
    ds_read_b128 v[108:111], v6 offset:7680
    s_waitcnt lgkmcnt(7)
    v_mfma_f32_16x16x32_bf16 v[112:115], a[32:35], v[80:83], v[112:115]
    v_mfma_f32_16x16x32_bf16 v[120:123], v[80:83], a[160:163], v[120:123]
    v_mfma_f32_16x16x32_bf16 v[116:119], a[96:99], v[80:83], v[116:119]
    v_mfma_f32_16x16x32_bf16 v[124:127], v[80:83], a[224:227], v[124:127]
    s_waitcnt lgkmcnt(6)
    v_mfma_f32_16x16x32_bf16 v[112:115], a[36:39], v[84:87], v[112:115]
    v_mfma_f32_16x16x32_bf16 v[120:123], v[84:87], a[164:167], v[120:123]
    v_mfma_f32_16x16x32_bf16 v[116:119], a[100:103], v[84:87], v[116:119]
    v_mfma_f32_16x16x32_bf16 v[124:127], v[84:87], a[228:231], v[124:127]
    s_waitcnt lgkmcnt(5)
    v_mfma_f32_16x16x32_bf16 v[112:115], a[40:43], v[88:91], v[112:115]
    v_mfma_f32_16x16x32_bf16 v[120:123], v[88:91], a[168:171], v[120:123]
    v_mfma_f32_16x16x32_bf16 v[116:119], a[104:107], v[88:91], v[116:119]
    v_mfma_f32_16x16x32_bf16 v[124:127], v[88:91], a[232:235], v[124:127]
    s_waitcnt lgkmcnt(4)
    v_mfma_f32_16x16x32_bf16 v[112:115], a[44:47], v[92:95], v[112:115]
    v_mfma_f32_16x16x32_bf16 v[120:123], v[92:95], a[172:175], v[120:123]
    v_mfma_f32_16x16x32_bf16 v[116:119], a[108:111], v[92:95], v[116:119]
    v_mfma_f32_16x16x32_bf16 v[124:127], v[92:95], a[236:239], v[124:127]
    s_waitcnt lgkmcnt(3)
    v_mfma_f32_16x16x32_bf16 v[112:115], a[48:51], v[96:99], v[112:115]
    v_mfma_f32_16x16x32_bf16 v[120:123], v[96:99], a[176:179], v[120:123]
    v_mfma_f32_16x16x32_bf16 v[116:119], a[112:115], v[96:99], v[116:119]
    v_mfma_f32_16x16x32_bf16 v[124:127], v[96:99], a[240:243], v[124:127]
    s_waitcnt lgkmcnt(2)
    v_mfma_f32_16x16x32_bf16 v[112:115], a[52:55], v[100:103], v[112:115]
    v_mfma_f32_16x16x32_bf16 v[120:123], v[100:103], a[180:183], v[120:123]
    v_mfma_f32_16x16x32_bf16 v[116:119], a[116:119], v[100:103], v[116:119]
    v_mfma_f32_16x16x32_bf16 v[124:127], v[100:103], a[244:247], v[124:127]
    s_waitcnt lgkmcnt(1)
    v_mfma_f32_16x16x32_bf16 v[112:115], a[56:59], v[104:107], v[112:115]
    v_mfma_f32_16x16x32_bf16 v[120:123], v[104:107], a[184:187], v[120:123]
    v_mfma_f32_16x16x32_bf16 v[116:119], a[120:123], v[104:107], v[116:119]
    v_mfma_f32_16x16x32_bf16 v[124:127], v[104:107], a[248:251], v[124:127]
    s_waitcnt lgkmcnt(0)
    v_mfma_f32_16x16x32_bf16 v[112:115], a[60:63], v[108:111], v[112:115]
    v_mfma_f32_16x16x32_bf16 v[120:123], v[108:111], a[188:191], v[120:123]
    v_mfma_f32_16x16x32_bf16 v[116:119], a[124:127], v[108:111], v[116:119]
    v_mfma_f32_16x16x32_bf16 v[124:127], v[108:111], a[252:255], v[124:127]
    s_nop 7
    v_cvt_pk_bf16_f32 v112, v112, v113
    v_cvt_pk_bf16_f32 v113, v114, v115
    v_cvt_pk_bf16_f32 v114, v116, v117
    v_cvt_pk_bf16_f32 v115, v118, v119
    v_cvt_pk_bf16_f32 v120, v120, v121
    v_cvt_pk_bf16_f32 v121, v122, v123
    v_cvt_pk_bf16_f32 v122, v124, v125
    v_cvt_pk_bf16_f32 v123, v126, v127
    ds_write_b128 v7, v[112:115]
    ds_write_b64 v8, v[120:121]
    ds_write_b64 v8, v[122:123] offset:512
    s_waitcnt lgkmcnt(0)
    s_barrier
    ds_read_b128 v[80:83], v1 offset:8192
    ds_read_b128 v[84:87], v1 offset:9216
    ds_read_b128 v[88:91], v1 offset:10240
    ds_read_b128 v[92:95], v1 offset:11264
    ds_read_b64 v[96:97], v9 offset:0
    ds_read_b64 v[98:99], v9 offset:512
    ds_read_b64 v[100:101], v9 offset:1024
    ds_read_b64 v[102:103], v9 offset:1536
    s_waitcnt lgkmcnt(0)
    v_mfma_f32_16x16x32_bf16 v[60:63], v[80:83], v[36:39], v[24:27]
    v_mfma_f32_16x16x32_bf16 v[60:63], v[84:87], v[40:43], v[60:63]
    v_mfma_f32_16x16x32_bf16 v[60:63], v[88:91], v[44:47], v[60:63]
    v_mfma_f32_16x16x32_bf16 v[60:63], v[92:95], v[48:51], v[60:63]
    v_max3_f32 v116, v52, v53, v54
    v_max3_f32 v117, v55, v56, v57
    v_max3_f32 v116, v116, v58, v59
    s_nop 4
    v_max3_f32 v117, v117, v60, v61
    v_max3_f32 v116, v116, v62, v63
    v_max_f32 v116, v116, v117
    v_max_f32 v117, v116, v117
    s_nop 1
    v_permlane32_swap_b32 v116, v117
    v_max_f32 v118, v116, v117
    v_max_f32 v119, v116, v117
    s_nop 1
    v_permlane16_swap_b32 v118, v119
    v_max_f32 v116, v118, v119
    v_mul_f32 v116, s35, v116
    v_fma_f32 v52, v52, s35, -v116
    v_fma_f32 v53, v53, s35, -v116
    v_fma_f32 v54, v54, s35, -v116
    v_fma_f32 v55, v55, s35, -v116
    v_fma_f32 v56, v56, s35, -v116
    v_fma_f32 v57, v57, s35, -v116
    v_fma_f32 v58, v58, s35, -v116
    v_fma_f32 v59, v59, s35, -v116
    v_fma_f32 v60, v60, s35, -v116
    v_fma_f32 v61, v61, s35, -v116
    v_fma_f32 v62, v62, s35, -v116
    v_fma_f32 v63, v63, s35, -v116
    v_exp_f32 v52, v52
    v_exp_f32 v53, v53
    v_exp_f32 v54, v54
    v_exp_f32 v55, v55
    v_exp_f32 v56, v56
    v_exp_f32 v57, v57
    v_exp_f32 v58, v58
    v_exp_f32 v59, v59
    v_exp_f32 v60, v60
    v_exp_f32 v61, v61
    v_exp_f32 v62, v62
    v_exp_f32 v63, v63
    v_cvt_pk_bf16_f32 v104, v52, v53
    v_cvt_pk_bf16_f32 v105, v54, v55
    v_cvt_pk_bf16_f32 v106, v56, v57
    v_cvt_pk_bf16_f32 v107, v58, v59
    v_cvt_pk_bf16_f32 v108, v60, v61
    v_cvt_pk_bf16_f32 v109, v62, v63
    s_nop 1
    v_mfma_f32_16x16x32_bf16 v[112:115], v[32:35], v[104:107], 0
    v_mfma_f32_16x16x32_bf16 v[36:39], v[64:67], v[104:107], 0
    v_mfma_f32_16x16x32_bf16 v[40:43], v[68:71], v[104:107], 0
    v_mfma_f32_16x16x32_bf16 v[44:47], v[72:75], v[104:107], 0
    v_mfma_f32_16x16x32_bf16 v[48:51], v[76:79], v[104:107], 0
    v_mfma_f32_16x16x16_bf16 v[112:115], v[32:33], v[108:109], v[112:115]
    v_mfma_f32_16x16x16_bf16 v[36:39], v[96:97], v[108:109], v[36:39]
    v_mfma_f32_16x16x16_bf16 v[40:43], v[98:99], v[108:109], v[40:43]
    v_mfma_f32_16x16x16_bf16 v[44:47], v[100:101], v[108:109], v[44:47]
    v_mfma_f32_16x16x16_bf16 v[48:51], v[102:103], v[108:109], v[48:51]
    s_nop 3
    v_rcp_f32 v116, v112
    s_nop 3
    v_mul_f32 v36, v36, v116
    v_mul_f32 v37, v37, v116
    v_mul_f32 v38, v38, v116
    v_mul_f32 v39, v39, v116
    v_mul_f32 v40, v40, v116
    v_mul_f32 v41, v41, v116
    v_mul_f32 v42, v42, v116
    v_mul_f32 v43, v43, v116
    v_mul_f32 v44, v44, v116
    v_mul_f32 v45, v45, v116
    v_mul_f32 v46, v46, v116
    v_mul_f32 v47, v47, v116
    v_mul_f32 v48, v48, v116
    v_mul_f32 v49, v49, v116
    v_mul_f32 v50, v50, v116
    v_mul_f32 v51, v51, v116
    v_cvt_pk_bf16_f32 v36, v36, v37
    v_cvt_pk_bf16_f32 v37, v38, v39
    v_cvt_pk_bf16_f32 v38, v40, v41
    v_cvt_pk_bf16_f32 v39, v42, v43
    v_cvt_pk_bf16_f32 v40, v44, v45
    v_cvt_pk_bf16_f32 v41, v46, v47
    v_cvt_pk_bf16_f32 v42, v48, v49
    v_cvt_pk_bf16_f32 v43, v50, v51
    ds_write_b128 v10, v[36:39]
    ds_write_b128 v10, v[40:43] offset:1024
    s_waitcnt lgkmcnt(0)
    s_barrier
    ds_read_b128 v[80:83], v1 offset:16384
    ds_read_b128 v[84:87], v1 offset:17408
    ds_read_b128 v[88:91], v1 offset:18432
    ds_read_b128 v[92:95], v1 offset:19456
    ds_read_b128 v[96:99], v1 offset:20480
    ds_read_b128 v[100:103], v1 offset:21504
    ds_read_b128 v[104:107], v1 offset:22528
    ds_read_b128 v[108:111], v1 offset:23552
    s_lshl_b32 s38, s33, 20
    s_add_u32 s38, s38, 0x4000000
    s_waitcnt lgkmcnt(0)
    v_mfma_f32_16x16x32_bf16 v[36:39], v[128:131], v[80:83], 0
    v_mfma_f32_16x16x32_bf16 v[40:43], v[144:147], v[80:83], 0
    v_mfma_f32_16x16x32_bf16 v[44:47], v[128:131], v[96:99], 0
    v_mfma_f32_16x16x32_bf16 v[48:51], v[144:147], v[96:99], 0
    v_mfma_f32_16x16x32_bf16 v[36:39], v[132:135], v[84:87], v[36:39]
    v_mfma_f32_16x16x32_bf16 v[40:43], v[148:151], v[84:87], v[40:43]
    v_mfma_f32_16x16x32_bf16 v[44:47], v[132:135], v[100:103], v[44:47]
    v_mfma_f32_16x16x32_bf16 v[48:51], v[148:151], v[100:103], v[48:51]
    v_mfma_f32_16x16x32_bf16 v[36:39], v[136:139], v[88:91], v[36:39]
    v_mfma_f32_16x16x32_bf16 v[40:43], v[152:155], v[88:91], v[40:43]
    v_mfma_f32_16x16x32_bf16 v[44:47], v[136:139], v[104:107], v[44:47]
    v_mfma_f32_16x16x32_bf16 v[48:51], v[152:155], v[104:107], v[48:51]
    v_mfma_f32_16x16x32_bf16 v[36:39], v[140:143], v[92:95], v[36:39]
    v_mfma_f32_16x16x32_bf16 v[40:43], v[156:159], v[92:95], v[40:43]
    v_mfma_f32_16x16x32_bf16 v[44:47], v[140:143], v[108:111], v[44:47]
    v_mfma_f32_16x16x32_bf16 v[48:51], v[156:159], v[108:111], v[48:51]
    v_mfma_f32_16x16x32_bf16 v[52:55], v[160:163], v[80:83], 0
    v_mfma_f32_16x16x32_bf16 v[56:59], v[176:179], v[80:83], 0
    v_mfma_f32_16x16x32_bf16 v[60:63], v[160:163], v[96:99], 0
    v_mfma_f32_16x16x32_bf16 v[64:67], v[176:179], v[96:99], 0
    v_mfma_f32_16x16x32_bf16 v[52:55], v[164:167], v[84:87], v[52:55]
    v_mfma_f32_16x16x32_bf16 v[56:59], v[180:183], v[84:87], v[56:59]
    v_mfma_f32_16x16x32_bf16 v[60:63], v[164:167], v[100:103], v[60:63]
    v_mfma_f32_16x16x32_bf16 v[64:67], v[180:183], v[100:103], v[64:67]
    v_cvt_pk_bf16_f32 v36, v36, v37
    v_cvt_pk_bf16_f32 v37, v38, v39
    v_cvt_pk_bf16_f32 v38, v40, v41
    v_cvt_pk_bf16_f32 v39, v42, v43
    v_or_b32 v36, 1, v36
    s_add_u32 s28, s38, 0x0
    buffer_store_dwordx4 v[36:39], v11, s[4:7], s28 offen sc0 sc1
    v_cvt_pk_bf16_f32 v44, v44, v45
    v_cvt_pk_bf16_f32 v45, v46, v47
    v_cvt_pk_bf16_f32 v46, v48, v49
    v_cvt_pk_bf16_f32 v47, v50, v51
    v_or_b32 v44, 1, v44
    s_add_u32 s28, s38, 0x8000
    buffer_store_dwordx4 v[44:47], v11, s[4:7], s28 offen sc0 sc1
    v_mfma_f32_16x16x32_bf16 v[52:55], v[168:171], v[88:91], v[52:55]
    v_mfma_f32_16x16x32_bf16 v[56:59], v[184:187], v[88:91], v[56:59]
    v_mfma_f32_16x16x32_bf16 v[60:63], v[168:171], v[104:107], v[60:63]
    v_mfma_f32_16x16x32_bf16 v[64:67], v[184:187], v[104:107], v[64:67]
    v_mfma_f32_16x16x32_bf16 v[52:55], v[172:175], v[92:95], v[52:55]
    v_mfma_f32_16x16x32_bf16 v[56:59], v[188:191], v[92:95], v[56:59]
    v_mfma_f32_16x16x32_bf16 v[60:63], v[172:175], v[108:111], v[60:63]
    v_mfma_f32_16x16x32_bf16 v[64:67], v[188:191], v[108:111], v[64:67]
    v_mfma_f32_16x16x32_bf16 v[36:39], v[192:195], v[80:83], 0
    v_mfma_f32_16x16x32_bf16 v[40:43], v[208:211], v[80:83], 0
    v_mfma_f32_16x16x32_bf16 v[44:47], v[192:195], v[96:99], 0
    v_mfma_f32_16x16x32_bf16 v[48:51], v[208:211], v[96:99], 0
    v_mfma_f32_16x16x32_bf16 v[36:39], v[196:199], v[84:87], v[36:39]
    v_mfma_f32_16x16x32_bf16 v[40:43], v[212:215], v[84:87], v[40:43]
    v_mfma_f32_16x16x32_bf16 v[44:47], v[196:199], v[100:103], v[44:47]
    v_mfma_f32_16x16x32_bf16 v[48:51], v[212:215], v[100:103], v[48:51]
    v_cvt_pk_bf16_f32 v52, v52, v53
    v_cvt_pk_bf16_f32 v53, v54, v55
    v_cvt_pk_bf16_f32 v54, v56, v57
    v_cvt_pk_bf16_f32 v55, v58, v59
    v_or_b32 v52, 1, v52
    s_add_u32 s28, s38, 0x10000
    buffer_store_dwordx4 v[52:55], v11, s[4:7], s28 offen sc0 sc1
    v_cvt_pk_bf16_f32 v60, v60, v61
    v_cvt_pk_bf16_f32 v61, v62, v63
    v_cvt_pk_bf16_f32 v62, v64, v65
    v_cvt_pk_bf16_f32 v63, v66, v67
    v_or_b32 v60, 1, v60
    s_add_u32 s28, s38, 0x18000
    buffer_store_dwordx4 v[60:63], v11, s[4:7], s28 offen sc0 sc1
    v_mfma_f32_16x16x32_bf16 v[36:39], v[200:203], v[88:91], v[36:39]
    v_mfma_f32_16x16x32_bf16 v[40:43], v[216:219], v[88:91], v[40:43]
    v_mfma_f32_16x16x32_bf16 v[44:47], v[200:203], v[104:107], v[44:47]
    v_mfma_f32_16x16x32_bf16 v[48:51], v[216:219], v[104:107], v[48:51]
    v_mfma_f32_16x16x32_bf16 v[36:39], v[204:207], v[92:95], v[36:39]
    v_mfma_f32_16x16x32_bf16 v[40:43], v[220:223], v[92:95], v[40:43]
    v_mfma_f32_16x16x32_bf16 v[44:47], v[204:207], v[108:111], v[44:47]
    v_mfma_f32_16x16x32_bf16 v[48:51], v[220:223], v[108:111], v[48:51]
    v_mfma_f32_16x16x32_bf16 v[52:55], v[224:227], v[80:83], 0
    v_mfma_f32_16x16x32_bf16 v[56:59], v[240:243], v[80:83], 0
    v_mfma_f32_16x16x32_bf16 v[60:63], v[224:227], v[96:99], 0
    v_mfma_f32_16x16x32_bf16 v[64:67], v[240:243], v[96:99], 0
    v_mfma_f32_16x16x32_bf16 v[52:55], v[228:231], v[84:87], v[52:55]
    v_mfma_f32_16x16x32_bf16 v[56:59], v[244:247], v[84:87], v[56:59]
    v_mfma_f32_16x16x32_bf16 v[60:63], v[228:231], v[100:103], v[60:63]
    v_mfma_f32_16x16x32_bf16 v[64:67], v[244:247], v[100:103], v[64:67]
    v_cvt_pk_bf16_f32 v36, v36, v37
    v_cvt_pk_bf16_f32 v37, v38, v39
    v_cvt_pk_bf16_f32 v38, v40, v41
    v_cvt_pk_bf16_f32 v39, v42, v43
    v_or_b32 v36, 1, v36
    s_add_u32 s28, s38, 0x20000
    buffer_store_dwordx4 v[36:39], v11, s[4:7], s28 offen sc0 sc1
    v_cvt_pk_bf16_f32 v44, v44, v45
    v_cvt_pk_bf16_f32 v45, v46, v47
    v_cvt_pk_bf16_f32 v46, v48, v49
    v_cvt_pk_bf16_f32 v47, v50, v51
    v_or_b32 v44, 1, v44
    s_add_u32 s28, s38, 0x28000
    buffer_store_dwordx4 v[44:47], v11, s[4:7], s28 offen sc0 sc1
    v_mfma_f32_16x16x32_bf16 v[52:55], v[232:235], v[88:91], v[52:55]
    v_mfma_f32_16x16x32_bf16 v[56:59], v[248:251], v[88:91], v[56:59]
    v_mfma_f32_16x16x32_bf16 v[60:63], v[232:235], v[104:107], v[60:63]
    v_mfma_f32_16x16x32_bf16 v[64:67], v[248:251], v[104:107], v[64:67]
    v_mfma_f32_16x16x32_bf16 v[52:55], v[236:239], v[92:95], v[52:55]
    v_mfma_f32_16x16x32_bf16 v[56:59], v[252:255], v[92:95], v[56:59]
    v_mfma_f32_16x16x32_bf16 v[60:63], v[236:239], v[108:111], v[60:63]
    v_mfma_f32_16x16x32_bf16 v[64:67], v[252:255], v[108:111], v[64:67]
    s_nop 7
    v_cvt_pk_bf16_f32 v52, v52, v53
    v_cvt_pk_bf16_f32 v53, v54, v55
    v_cvt_pk_bf16_f32 v54, v56, v57
    v_cvt_pk_bf16_f32 v55, v58, v59
    v_or_b32 v52, 1, v52
    s_add_u32 s28, s38, 0x30000
    buffer_store_dwordx4 v[52:55], v11, s[4:7], s28 offen sc0 sc1
    v_cvt_pk_bf16_f32 v60, v60, v61
    v_cvt_pk_bf16_f32 v61, v62, v63
    v_cvt_pk_bf16_f32 v62, v64, v65
    v_cvt_pk_bf16_f32 v63, v66, v67
    v_or_b32 v60, 1, v60
    s_add_u32 s28, s38, 0x38000
    buffer_store_dwordx4 v[60:63], v11, s[4:7], s28 offen sc0 sc1
    s_mov_b32 s47, 0
    s_waitcnt vmcnt(8)
    s_branch L_w3f1
L_w3f:
    s_sleep 2
    buffer_load_dword v15, v14, s[4:7], s39 offen sc0 sc1
    s_add_u32 s47, s47, 1
    s_cmp_gt_u32 s47, 200000
    s_cbranch_scc1 L_end
    s_waitcnt vmcnt(0)
L_w3f1:
    v_cmp_ne_u32 vcc, s23, v15
    s_nop 0
    s_cbranch_vccnz L_w3f
    s_waitcnt vmcnt(0)
L_w3d:
    s_add_u32 s47, s47, 1
    s_cmp_gt_u32 s47, 200000
    s_cbranch_scc1 L_end
    s_add_u32 s28, s38, 0x0
    buffer_load_dwordx4 v[80:83], v12, s[4:7], s28 offen sc0 sc1
    s_add_u32 s28, s38, 0x1000
    buffer_load_dwordx4 v[84:87], v12, s[4:7], s28 offen sc0 sc1
    s_add_u32 s28, s38, 0x2000
    buffer_load_dwordx4 v[88:91], v12, s[4:7], s28 offen sc0 sc1
    s_add_u32 s28, s38, 0x3000
    buffer_load_dwordx4 v[92:95], v12, s[4:7], s28 offen sc0 sc1
    s_add_u32 s28, s38, 0x4000
    buffer_load_dwordx4 v[96:99], v12, s[4:7], s28 offen sc0 sc1
    s_add_u32 s28, s38, 0x5000
    buffer_load_dwordx4 v[100:103], v12, s[4:7], s28 offen sc0 sc1
    s_add_u32 s28, s38, 0x6000
    buffer_load_dwordx4 v[104:107], v12, s[4:7], s28 offen sc0 sc1
    s_add_u32 s28, s38, 0x7000
    buffer_load_dwordx4 v[108:111], v12, s[4:7], s28 offen sc0 sc1
    s_waitcnt vmcnt(7)
    v_mfma_f32_16x16x32_bf16 v[36:39], v[28:31], v[80:83], 0
    s_waitcnt vmcnt(6)
    v_mfma_f32_16x16x32_bf16 v[36:39], v[28:31], v[84:87], v[36:39]
    s_waitcnt vmcnt(5)
    v_mfma_f32_16x16x32_bf16 v[36:39], v[28:31], v[88:91], v[36:39]
    s_waitcnt vmcnt(4)
    v_mfma_f32_16x16x32_bf16 v[36:39], v[28:31], v[92:95], v[36:39]
    s_waitcnt vmcnt(3)
    v_mfma_f32_16x16x32_bf16 v[36:39], v[28:31], v[96:99], v[36:39]
    s_waitcnt vmcnt(2)
    v_mfma_f32_16x16x32_bf16 v[36:39], v[28:31], v[100:103], v[36:39]
    s_waitcnt vmcnt(1)
    v_mfma_f32_16x16x32_bf16 v[36:39], v[28:31], v[104:107], v[36:39]
    s_waitcnt vmcnt(0)
    v_mfma_f32_16x16x32_bf16 v[36:39], v[28:31], v[108:111], v[36:39]
    v_bitop3_b32 v15, v80, v84, v88 bitop3:0x80
    v_bitop3_b32 v14, v92, v96, v100 bitop3:0x80
    v_bitop3_b32 v15, v15, v104, v108 bitop3:0x80
    v_bitop3_b32 v15, v15, v14, 1 bitop3:0x80
    v_cmp_ne_u32 vcc, 1, v15
    s_nop 0
    s_cbranch_vccnz L_w3d
    s_lshl_b32 s28, s33, 16
    s_nop 7
    v_cvt_pk_bf16_f32 v36, v36, v37
    v_cvt_pk_bf16_f32 v37, v38, v39
    s_mov_b32 exec_hi, 0
    buffer_store_dwordx2 v[36:37], v13, s[12:15], s28 offen
    s_mov_b64 exec, -1
    s_add_u32 s33, s33, 7
    s_cmp_lt_u32 s33, 64
    s_cbranch_scc1 L_w3loop
    s_branch L_end
L_head:
    s_mov_b32 s24, s22
    v_lshrrev_b32 v112, 4, v0
    v_and_b32 v113, 15, v0
    v_bfe_u32 v114, v0, 2, 2
    v_and_b32 v115, 3, v0
    v_bfe_u32 v124, v0, 2, 1
    v_lshlrev_b32 v0, 4, v0
    v_add_u32 v2, s27, v0
    s_lshl_b32 s28, s24, 17
    v_add_u32 v25, s28, v2
    v_lshrrev_b32 v116, 1, v112
    v_and_b32 v117, 1, v112
    v_cmp_gt_u32 vcc, 8, v113
    s_lshl_b32 s28, s20, 3
    v_lshl_add_u32 v118, v116, 1, s28
    s_mov_b64 s[42:43], vcc
    v_lshrrev_b32 v119, 3, v113
    v_add_u32 v118, v118, v119
    v_mul_u32_u24 v118, 9216, v118
    v_and_b32 v120, 7, v113
    v_lshl_add_u32 v121, v117, 3, v120
    v_lshl_add_u32 v118, v121, 4, v118
    s_lshl_b32 s28, s24, 8
    v_add_u32 v7, s28, v118
    v_lshlrev_b32 v118, 3, v124
    v_lshl_add_u32 v118, v116, 2, v118
    v_add_u32 v118, v118, v115
    v_lshlrev_b32 v118, 4, v118
    v_lshl_add_u32 v118, v117, 3, v118
    v_add_u32 v8, s28, v118
    s_mov_b32 s38, 0x4c000
    s_mov_b32 s39, 0x4d000
    s_mov_b32 s44, 36864
    s_mul_i32 s36, s24, 9216
    s_add_u32 s37, s36, 0x1000
    v_mov_b32 v28, 0
    v_mov_b32 v29, 0
    v_mov_b32 v30, 0
    v_mov_b32 v31, 0
    s_mov_b32 s12, s66
    s_and_b32 s13, s67, 0xffff
    s_mov_b32 s14, 0x2000
    s_mov_b32 s15, 0x00020000
    v_lshl_add_u32 v118, v116, 2, v115
    v_lshlrev_b32 v118, 10, v118
    v_lshl_add_u32 v118, v124, 4, v118
    v_lshl_add_u32 v118, v117, 3, v118
    s_lshl_b32 s28, s24, 5
    s_mov_b64 exec, s[42:43]
    buffer_load_dwordx2 v[32:33], v118, s[12:15], s28 offen
    s_mov_b64 exec, -1
    s_cmp_eq_u32 s3, 0
    s_cbranch_scc1 L_lw_6
    s_lshl_b32 s28, 1, s22
    v_mov_b32 v36, s23
    v_mov_b32 v37, 0
    v_mov_b32 v38, s28
    s_lshl_b32 s28, s21, 2
    v_mov_b32 v39, s28
    v_mov_b32 v40, 32
    s_mov_b64 exec, 1
    buffer_atomic_cmpswap v[36:37], v40, s[8:11], 0 offen sc0 sc1
    buffer_atomic_or v38, v39, s[8:11], 0 offen offset:0 sc0 sc1
    s_mov_b64 exec, -1
L_lw_6:
    s_mov_b32 s16, s74
    s_and_b32 s17, s75, 0xffff
    s_mov_b32 s18, 0x400000
    s_mov_b32 s19, 0x00020000
    s_add_u32 m0, s27, 0x8000
    s_mov_b32 s28, 0x0
    buffer_load_dwordx4 v25, s[16:19], s28 offen lds
    s_add_u32 m0, s27, 0x9000
    s_mov_b32 s28, 0x1000
    buffer_load_dwordx4 v25, s[16:19], s28 offen lds
    s_add_u32 m0, s27, 0xa000
    s_mov_b32 s28, 0x2000
    buffer_load_dwordx4 v25, s[16:19], s28 offen lds
    s_add_u32 m0, s27, 0xb000
    s_mov_b32 s28, 0x3000
    buffer_load_dwordx4 v25, s[16:19], s28 offen lds
    s_add_u32 m0, s27, 0xc000
    s_mov_b32 s28, 0x4000
    buffer_load_dwordx4 v25, s[16:19], s28 offen lds
    s_add_u32 m0, s27, 0xd000
    s_mov_b32 s28, 0x5000
    buffer_load_dwordx4 v25, s[16:19], s28 offen lds
    s_add_u32 m0, s27, 0xe000
    s_mov_b32 s28, 0x6000
    buffer_load_dwordx4 v25, s[16:19], s28 offen lds
    s_add_u32 m0, s27, 0xf000
    s_mov_b32 s28, 0x7000
    buffer_load_dwordx4 v25, s[16:19], s28 offen lds
    s_add_u32 m0, s27, 0x10000
    s_mov_b32 s28, 0x8000
    buffer_load_dwordx4 v25, s[16:19], s28 offen lds
    s_add_u32 m0, s27, 0x11000
    s_mov_b32 s28, 0x9000
    buffer_load_dwordx4 v25, s[16:19], s28 offen lds
    s_add_u32 m0, s27, 0x12000
    s_mov_b32 s28, 0xa000
    buffer_load_dwordx4 v25, s[16:19], s28 offen lds
    s_add_u32 m0, s27, 0x13000
    s_mov_b32 s28, 0xb000
    buffer_load_dwordx4 v25, s[16:19], s28 offen lds
    s_add_u32 m0, s27, 0x14000
    s_mov_b32 s28, 0xc000
    buffer_load_dwordx4 v25, s[16:19], s28 offen lds
    s_add_u32 m0, s27, 0x15000
    s_mov_b32 s28, 0xd000
    buffer_load_dwordx4 v25, s[16:19], s28 offen lds
    s_add_u32 m0, s27, 0x16000
    s_mov_b32 s28, 0xe000
    buffer_load_dwordx4 v25, s[16:19], s28 offen lds
    s_add_u32 m0, s27, 0x17000
    s_mov_b32 s28, 0xf000
    buffer_load_dwordx4 v25, s[16:19], s28 offen lds
    s_add_u32 m0, s27, 0x18000
    s_mov_b32 s28, 0x10000
    buffer_load_dwordx4 v25, s[16:19], s28 offen lds
    s_add_u32 m0, s27, 0x19000
    s_mov_b32 s28, 0x11000
    buffer_load_dwordx4 v25, s[16:19], s28 offen lds
    s_add_u32 m0, s27, 0x1a000
    s_mov_b32 s28, 0x12000
    buffer_load_dwordx4 v25, s[16:19], s28 offen lds
    s_add_u32 m0, s27, 0x1b000
    s_mov_b32 s28, 0x13000
    buffer_load_dwordx4 v25, s[16:19], s28 offen lds
    s_add_u32 m0, s27, 0x1c000
    s_mov_b32 s28, 0x14000
    buffer_load_dwordx4 v25, s[16:19], s28 offen lds
    s_add_u32 m0, s27, 0x1d000
    s_mov_b32 s28, 0x15000
    buffer_load_dwordx4 v25, s[16:19], s28 offen lds
    s_add_u32 m0, s27, 0x1e000
    s_mov_b32 s28, 0x16000
    buffer_load_dwordx4 v25, s[16:19], s28 offen lds
    s_add_u32 m0, s27, 0x1f000
    s_mov_b32 s28, 0x17000
    buffer_load_dwordx4 v25, s[16:19], s28 offen lds
    s_add_u32 m0, s27, 0x20000
    s_mov_b32 s28, 0x18000
    buffer_load_dwordx4 v25, s[16:19], s28 offen lds
    s_add_u32 m0, s27, 0x21000
    s_mov_b32 s28, 0x19000
    buffer_load_dwordx4 v25, s[16:19], s28 offen lds
    s_add_u32 m0, s27, 0x22000
    s_mov_b32 s28, 0x1a000
    buffer_load_dwordx4 v25, s[16:19], s28 offen lds
    s_add_u32 m0, s27, 0x23000
    s_mov_b32 s28, 0x1b000
    buffer_load_dwordx4 v25, s[16:19], s28 offen lds
    s_add_u32 m0, s27, 0x24000
    s_mov_b32 s28, 0x1c000
    buffer_load_dwordx4 v25, s[16:19], s28 offen lds
    s_add_u32 m0, s27, 0x25000
    s_mov_b32 s28, 0x1d000
    buffer_load_dwordx4 v25, s[16:19], s28 offen lds
    s_add_u32 m0, s27, 0x26000
    s_mov_b32 s28, 0x1e000
    buffer_load_dwordx4 v25, s[16:19], s28 offen lds
    s_add_u32 m0, s27, 0x27000
    s_mov_b32 s28, 0x1f000
    buffer_load_dwordx4 v25, s[16:19], s28 offen lds
    s_cmp_eq_u32 s3, 0
    s_cbranch_scc1 L_lw_7a
    s_waitcnt vmcnt(16)
    v_readfirstlane_b32 s28, v36
L_lw_7c:
    v_mov_b32 v40, 0x100
    s_cmp_eq_u32 s28, 0
    s_cselect_b32 s28, s23, s28
    v_mov_b32 v39, s28
    s_mov_b64 exec, 1
    ds_write_b64 v40, v[38:39]
    s_mov_b64 exec, -1
    s_waitcnt lgkmcnt(0)
L_lw_7a:
    s_waitcnt vmcnt(16)
L_lw_7b:
    s_barrier
    s_cmp_eq_u32 s101, 0
    s_cbranch_scc1 L_vf_8
    v_mov_b32 v40, 0x100
    ds_read_b64 v[38:39], v40
    s_waitcnt lgkmcnt(0)
    v_readfirstlane_b32 s28, v38
    v_readfirstlane_b32 s23, v39
    s_bitcmp1_b32 s28, s22
    s_cbranch_scc1 L_slow
L_vf_8:
    v_mov_b32 v118, 0x4444
    v_mov_b32 v1, 0xeeee
    v_cndmask_b32 v1, v1, v118, s[42:43]
    s_lshl_b32 s28, s20, 1
    v_or_b32 v118, s28, v117
    v_lshlrev_b32 v118, 1, v118
    v_xor_b32 v118, v118, v113
    v_lshlrev_b32 v118, 4, v118
    s_lshl_b32 s28, s20, 2
    v_add_u32 v119, s28, v112
    v_lshlrev_b32 v119, 13, v119
    s_lshl_b32 s28, s24, 8
    v_add3_u32 v24, v118, v119, s28
    v_lshrrev_b32 v120, 1, v114
    v_and_b32 v121, 1, v114
    v_lshl_add_u32 v118, v116, 4, v121
    v_lshl_add_u32 v118, v120, 3, v118
    v_lshl_add_u32 v118, v117, 2, v118
    v_lshl_add_u32 v119, v117, 1, v121
    v_lshl_add_u32 v119, v120, 2, v119
    s_lshl_b32 s28, s20, 1
    v_xor_b32 v119, s28, v119
    v_lshlrev_b32 v119, 5, v119
    v_lshl_add_u32 v119, v115, 3, v119
    v_lshl_add_u32 v119, v118, 8, v119
    s_lshl_b32 s28, s20, 14
    v_add_u32 v26, s28, v119
    s_add_u32 s28, s28, 0x8000
    v_add_u32 v3, s28, v0
    v_add_u32 v4, 0x10000, v3
    v_lshlrev_b32 v27, 10, v118
    v_lshl_add_u32 v27, v120, 6, v27
    v_lshrrev_b32 v119, 1, v115
    v_lshl_add_u32 v27, v119, 5, v27
    v_and_b32 v119, 1, v115
    v_lshl_add_u32 v27, v119, 3, v27
    s_lshl_b32 s28, s20, 8
    v_add_u32 v27, s28, v27
    v_and_b32 v118, 7, v113
    v_mul_u32_u24 v118, 272, v118
    v_lshrrev_b32 v119, 3, v113
    v_lshl_add_u32 v120, v112, 3, v118
    v_lshl_add_u32 v120, v119, 5, v120
    s_lshl_b32 s28, s20, 6
    v_add_u32 v5, s28, v120
    v_lshl_add_u32 v118, v112, 5, v118
    v_lshl_add_u32 v6, v119, 4, v118
    v_and_b32 v118, 1, v113
    v_lshlrev_b32 v118, 4, v118
    v_mov_b32 v119, 0x3f80
    v_lshlrev_b32 v118, v118, v119
    v_lshrrev_b32 v119, 1, v113
    v_and_b32 v120, 3, v119
    v_lshlrev_b32 v121, 1, v117
    v_xor_b32 v120, v120, v121
    v_cmp_eq_u32 vcc, 0, v119
    v_mov_b32 v12, 0x3f003f00
    s_nop 0
    v_cndmask_b32 v16, 0, v118, vcc
    v_cmp_eq_u32 vcc, 1, v119
    v_mov_b32 v13, 0x3f003f00
    s_nop 0
    v_cndmask_b32 v17, 0, v118, vcc
    v_cmp_eq_u32 vcc, 2, v119
    v_mov_b32 v14, 0x3f003f00
    s_nop 0
    v_cndmask_b32 v18, 0, v118, vcc
    v_cmp_eq_u32 vcc, 3, v119
    v_mov_b32 v15, 0x3f003f00
    s_nop 0
    v_cndmask_b32 v19, 0, v118, vcc
    v_cmp_eq_u32 vcc, 0, v120
    s_nop 1
    v_cndmask_b32 v10, 0, v118, vcc
    v_cmp_eq_u32 vcc, 1, v120
    s_nop 1
    v_cndmask_b32 v11, 0, v118, vcc
    buffer_store_dwordx4 v[28:31], v7, s[4:7], 0 offen sc0 sc1
    buffer_store_dwordx4 v[28:31], v7, s[4:7], s44 offen sc0 sc1
    s_mov_b64 exec, s[42:43]
    buffer_store_dwordx2 v[28:29], v8, s[4:7], s38 offen sc0 sc1
    s_mov_b64 exec, -1
    v_xor_b32 v9, 0x0, v27
    v_add_u32 v9, 0x8000, v9
    ds_read_b64_tr_b16 v[128:129], v9 offset:0
    ds_read_b64_tr_b16 v[130:131], v9 offset:2048
    ds_read_b64_tr_b16 v[132:133], v9 offset:32768
    ds_read_b64_tr_b16 v[134:135], v9 offset:34816
    ds_read_b64_tr_b16 v[160:161], v9 offset:16
    ds_read_b64_tr_b16 v[162:163], v9 offset:2064
    ds_read_b64_tr_b16 v[164:165], v9 offset:32784
    ds_read_b64_tr_b16 v[166:167], v9 offset:34832
    ds_read_b64_tr_b16 v[192:193], v9 offset:128
    ds_read_b64_tr_b16 v[194:195], v9 offset:2176
    ds_read_b64_tr_b16 v[196:197], v9 offset:32896
    ds_read_b64_tr_b16 v[198:199], v9 offset:34944
    ds_read_b64_tr_b16 v[224:225], v9 offset:144
    ds_read_b64_tr_b16 v[226:227], v9 offset:2192
    ds_read_b64_tr_b16 v[228:229], v9 offset:32912
    ds_read_b64_tr_b16 v[230:231], v9 offset:34960
    v_xor_b32 v9, 0x2000, v27
    v_add_u32 v9, 0x8000, v9
    ds_read_b64_tr_b16 v[136:137], v9 offset:0
    ds_read_b64_tr_b16 v[138:139], v9 offset:2048
    ds_read_b64_tr_b16 v[140:141], v9 offset:32768
    ds_read_b64_tr_b16 v[142:143], v9 offset:34816
    ds_read_b64_tr_b16 v[168:169], v9 offset:16
    ds_read_b64_tr_b16 v[170:171], v9 offset:2064
    ds_read_b64_tr_b16 v[172:173], v9 offset:32784
    ds_read_b64_tr_b16 v[174:175], v9 offset:34832
    ds_read_b64_tr_b16 v[200:201], v9 offset:128
    ds_read_b64_tr_b16 v[202:203], v9 offset:2176
    ds_read_b64_tr_b16 v[204:205], v9 offset:32896
    ds_read_b64_tr_b16 v[206:207], v9 offset:34944
    ds_read_b64_tr_b16 v[232:233], v9 offset:144
    ds_read_b64_tr_b16 v[234:235], v9 offset:2192
    ds_read_b64_tr_b16 v[236:237], v9 offset:32912
    ds_read_b64_tr_b16 v[238:239], v9 offset:34960
    s_waitcnt lgkmcnt(0)
    s_barrier
    s_mov_b32 s12, s68
    s_and_b32 s13, s69, 0xffff
    s_mov_b32 s14, 0x400000
    s_mov_b32 s15, 0x00020000
    s_add_u32 m0, s27, 0x8000
    s_mov_b32 s28, 0x0
    buffer_load_dwordx4 v24, s[12:15], s28 offen lds
    s_add_u32 m0, s27, 0x9000
    s_mov_b32 s28, 0x20000
    buffer_load_dwordx4 v24, s[12:15], s28 offen lds
    s_add_u32 m0, s27, 0xa000
    s_mov_b32 s28, 0x40000
    buffer_load_dwordx4 v24, s[12:15], s28 offen lds
    s_add_u32 m0, s27, 0xb000
    s_mov_b32 s28, 0x60000
    buffer_load_dwordx4 v24, s[12:15], s28 offen lds
    s_add_u32 m0, s27, 0xc000
    s_mov_b32 s28, 0x80000
    buffer_load_dwordx4 v24, s[12:15], s28 offen lds
    s_add_u32 m0, s27, 0xd000
    s_mov_b32 s28, 0xa0000
    buffer_load_dwordx4 v24, s[12:15], s28 offen lds
    s_add_u32 m0, s27, 0xe000
    s_mov_b32 s28, 0xc0000
    buffer_load_dwordx4 v24, s[12:15], s28 offen lds
    s_add_u32 m0, s27, 0xf000
    s_mov_b32 s28, 0xe0000
    buffer_load_dwordx4 v24, s[12:15], s28 offen lds
    s_add_u32 m0, s27, 0x10000
    s_mov_b32 s28, 0x100000
    buffer_load_dwordx4 v24, s[12:15], s28 offen lds
    s_add_u32 m0, s27, 0x11000
    s_mov_b32 s28, 0x120000
    buffer_load_dwordx4 v24, s[12:15], s28 offen lds
    s_add_u32 m0, s27, 0x12000
    s_mov_b32 s28, 0x140000
    buffer_load_dwordx4 v24, s[12:15], s28 offen lds
    s_add_u32 m0, s27, 0x13000
    s_mov_b32 s28, 0x160000
    buffer_load_dwordx4 v24, s[12:15], s28 offen lds
    s_add_u32 m0, s27, 0x14000
    s_mov_b32 s28, 0x180000
    buffer_load_dwordx4 v24, s[12:15], s28 offen lds
    s_add_u32 m0, s27, 0x15000
    s_mov_b32 s28, 0x1a0000
    buffer_load_dwordx4 v24, s[12:15], s28 offen lds
    s_add_u32 m0, s27, 0x16000
    s_mov_b32 s28, 0x1c0000
    buffer_load_dwordx4 v24, s[12:15], s28 offen lds
    s_add_u32 m0, s27, 0x17000
    s_mov_b32 s28, 0x1e0000
    buffer_load_dwordx4 v24, s[12:15], s28 offen lds
    s_waitcnt vmcnt(16)
    s_barrier
    s_cmp_lg_u32 s20, 0
    s_cbranch_scc1 L_hi2
    s_cmp_lg_u32 s26, 0
    s_cselect_b32 s28, 0x10001, 1
    v_mov_b32 v28, s28
    v_mov_b32 v29, 36
    v_mov_b32 v34, s23
    v_mov_b32 v35, s23
    v_lshlrev_b32 v9, 1, v8
    s_mov_b32 s46, 0x100000
    s_mov_b64 exec, s[42:43]
    buffer_store_dwordx4 v[32:35], v9, s[4:7], s46 offen sc0 sc1
    s_mov_b64 exec, 1
    buffer_atomic_add v28, v29, s[8:11], 0 offen sc1
    s_mov_b64 exec, -1
L_hi2:
    v_xor_b32 v9, 0x0, v27
    v_add_u32 v9, 0x18000, v9
    ds_read_b64_tr_b16 v[144:145], v9 offset:0
    ds_read_b64_tr_b16 v[146:147], v9 offset:2048
    ds_read_b64_tr_b16 v[148:149], v9 offset:32768
    ds_read_b64_tr_b16 v[150:151], v9 offset:34816
    ds_read_b64_tr_b16 v[176:177], v9 offset:16
    ds_read_b64_tr_b16 v[178:179], v9 offset:2064
    ds_read_b64_tr_b16 v[180:181], v9 offset:32784
    ds_read_b64_tr_b16 v[182:183], v9 offset:34832
    ds_read_b64_tr_b16 v[208:209], v9 offset:128
    ds_read_b64_tr_b16 v[210:211], v9 offset:2176
    ds_read_b64_tr_b16 v[212:213], v9 offset:32896
    ds_read_b64_tr_b16 v[214:215], v9 offset:34944
    ds_read_b64_tr_b16 v[240:241], v9 offset:144
    ds_read_b64_tr_b16 v[242:243], v9 offset:2192
    ds_read_b64_tr_b16 v[244:245], v9 offset:32912
    ds_read_b64_tr_b16 v[246:247], v9 offset:34960
    v_xor_b32 v9, 0x2000, v27
    v_add_u32 v9, 0x18000, v9
    ds_read_b64_tr_b16 v[152:153], v9 offset:0
    ds_read_b64_tr_b16 v[154:155], v9 offset:2048
    ds_read_b64_tr_b16 v[156:157], v9 offset:32768
    ds_read_b64_tr_b16 v[158:159], v9 offset:34816
    ds_read_b64_tr_b16 v[184:185], v9 offset:16
    ds_read_b64_tr_b16 v[186:187], v9 offset:2064
    ds_read_b64_tr_b16 v[188:189], v9 offset:32784
    ds_read_b64_tr_b16 v[190:191], v9 offset:34832
    ds_read_b64_tr_b16 v[216:217], v9 offset:128
    ds_read_b64_tr_b16 v[218:219], v9 offset:2176
    ds_read_b64_tr_b16 v[220:221], v9 offset:32896
    ds_read_b64_tr_b16 v[222:223], v9 offset:34944
    ds_read_b64_tr_b16 v[248:249], v9 offset:144
    ds_read_b64_tr_b16 v[250:251], v9 offset:2192
    ds_read_b64_tr_b16 v[252:253], v9 offset:32912
    ds_read_b64_tr_b16 v[254:255], v9 offset:34960
    s_waitcnt lgkmcnt(0)
    s_barrier
    s_add_u32 m0, s27, 0x18000
    s_mov_b32 s28, 0x200000
    buffer_load_dwordx4 v24, s[12:15], s28 offen lds
    s_add_u32 m0, s27, 0x19000
    s_mov_b32 s28, 0x220000
    buffer_load_dwordx4 v24, s[12:15], s28 offen lds
    s_add_u32 m0, s27, 0x1a000
    s_mov_b32 s28, 0x240000
    buffer_load_dwordx4 v24, s[12:15], s28 offen lds
    s_add_u32 m0, s27, 0x1b000
    s_mov_b32 s28, 0x260000
    buffer_load_dwordx4 v24, s[12:15], s28 offen lds
    s_add_u32 m0, s27, 0x1c000
    s_mov_b32 s28, 0x280000
    buffer_load_dwordx4 v24, s[12:15], s28 offen lds
    s_add_u32 m0, s27, 0x1d000
    s_mov_b32 s28, 0x2a0000
    buffer_load_dwordx4 v24, s[12:15], s28 offen lds
    s_add_u32 m0, s27, 0x1e000
    s_mov_b32 s28, 0x2c0000
    buffer_load_dwordx4 v24, s[12:15], s28 offen lds
    s_add_u32 m0, s27, 0x1f000
    s_mov_b32 s28, 0x2e0000
    buffer_load_dwordx4 v24, s[12:15], s28 offen lds
    s_add_u32 m0, s27, 0x20000
    s_mov_b32 s28, 0x300000
    buffer_load_dwordx4 v24, s[12:15], s28 offen lds
    s_add_u32 m0, s27, 0x21000
    s_mov_b32 s28, 0x320000
    buffer_load_dwordx4 v24, s[12:15], s28 offen lds
    s_add_u32 m0, s27, 0x22000
    s_mov_b32 s28, 0x340000
    buffer_load_dwordx4 v24, s[12:15], s28 offen lds
    s_add_u32 m0, s27, 0x23000
    s_mov_b32 s28, 0x360000
    buffer_load_dwordx4 v24, s[12:15], s28 offen lds
    s_add_u32 m0, s27, 0x24000
    s_mov_b32 s28, 0x380000
    buffer_load_dwordx4 v24, s[12:15], s28 offen lds
    s_add_u32 m0, s27, 0x25000
    s_mov_b32 s28, 0x3a0000
    buffer_load_dwordx4 v24, s[12:15], s28 offen lds
    s_add_u32 m0, s27, 0x26000
    s_mov_b32 s28, 0x3c0000
    buffer_load_dwordx4 v24, s[12:15], s28 offen lds
    s_add_u32 m0, s27, 0x27000
    s_mov_b32 s28, 0x3e0000
    buffer_load_dwordx4 v24, s[12:15], s28 offen lds
    s_waitcnt vmcnt(16)
    s_barrier
    v_xor_b32 v9, 0x0, v26
    v_add_u32 v9, 0x0, v9
    ds_read_b64_tr_b16 a[0:1], v9 offset:32768
    ds_read_b64_tr_b16 a[2:3], v9 offset:33280
    ds_read_b64_tr_b16 a[4:5], v9 offset:40960
    ds_read_b64_tr_b16 a[6:7], v9 offset:41472
    v_xor_b32 v9, 0x20, v26
    v_add_u32 v9, 0x0, v9
    ds_read_b64_tr_b16 a[8:9], v9 offset:32768
    ds_read_b64_tr_b16 a[10:11], v9 offset:33280
    ds_read_b64_tr_b16 a[12:13], v9 offset:40960
    ds_read_b64_tr_b16 a[14:15], v9 offset:41472
    v_xor_b32 v9, 0x4000, v26
    v_add_u32 v9, 0x0, v9
    ds_read_b64_tr_b16 a[32:33], v9 offset:32768
    ds_read_b64_tr_b16 a[34:35], v9 offset:33280
    ds_read_b64_tr_b16 a[36:37], v9 offset:40960
    ds_read_b64_tr_b16 a[38:39], v9 offset:41472
    v_xor_b32 v9, 0x4020, v26
    v_add_u32 v9, 0x0, v9
    ds_read_b64_tr_b16 a[40:41], v9 offset:32768
    ds_read_b64_tr_b16 a[42:43], v9 offset:33280
    ds_read_b64_tr_b16 a[44:45], v9 offset:40960
    ds_read_b64_tr_b16 a[46:47], v9 offset:41472
    v_xor_b32 v9, 0x8000, v26
    v_add_u32 v9, 0x0, v9
    ds_read_b64_tr_b16 a[64:65], v9 offset:32768
    ds_read_b64_tr_b16 a[66:67], v9 offset:33280
    ds_read_b64_tr_b16 a[68:69], v9 offset:40960
    ds_read_b64_tr_b16 a[70:71], v9 offset:41472
    v_xor_b32 v9, 0x8020, v26
    v_add_u32 v9, 0x0, v9
    ds_read_b64_tr_b16 a[72:73], v9 offset:32768
    ds_read_b64_tr_b16 a[74:75], v9 offset:33280
    ds_read_b64_tr_b16 a[76:77], v9 offset:40960
    ds_read_b64_tr_b16 a[78:79], v9 offset:41472
    v_xor_b32 v9, 0xc000, v26
    v_add_u32 v9, 0x0, v9
    ds_read_b64_tr_b16 a[96:97], v9 offset:32768
    ds_read_b64_tr_b16 a[98:99], v9 offset:33280
    ds_read_b64_tr_b16 a[100:101], v9 offset:40960
    ds_read_b64_tr_b16 a[102:103], v9 offset:41472
    v_xor_b32 v9, 0xc020, v26
    v_add_u32 v9, 0x0, v9
    ds_read_b64_tr_b16 a[104:105], v9 offset:32768
    ds_read_b64_tr_b16 a[106:107], v9 offset:33280
    ds_read_b64_tr_b16 a[108:109], v9 offset:40960
    ds_read_b64_tr_b16 a[110:111], v9 offset:41472
    s_waitcnt lgkmcnt(0)
    s_barrier
    s_mov_b32 s16, s70
    s_and_b32 s17, s71, 0xffff
    s_mov_b32 s18, 0x400000
    s_mov_b32 s19, 0x00020000
    s_add_u32 m0, s27, 0x8000
    s_mov_b32 s28, 0x0
    buffer_load_dwordx4 v24, s[16:19], s28 offen lds
    s_add_u32 m0, s27, 0x9000
    s_mov_b32 s28, 0x20000
    buffer_load_dwordx4 v24, s[16:19], s28 offen lds
    s_add_u32 m0, s27, 0xa000
    s_mov_b32 s28, 0x40000
    buffer_load_dwordx4 v24, s[16:19], s28 offen lds
    s_add_u32 m0, s27, 0xb000
    s_mov_b32 s28, 0x60000
    buffer_load_dwordx4 v24, s[16:19], s28 offen lds
    s_add_u32 m0, s27, 0xc000
    s_mov_b32 s28, 0x80000
    buffer_load_dwordx4 v24, s[16:19], s28 offen lds
    s_add_u32 m0, s27, 0xd000
    s_mov_b32 s28, 0xa0000
    buffer_load_dwordx4 v24, s[16:19], s28 offen lds
    s_add_u32 m0, s27, 0xe000
    s_mov_b32 s28, 0xc0000
    buffer_load_dwordx4 v24, s[16:19], s28 offen lds
    s_add_u32 m0, s27, 0xf000
    s_mov_b32 s28, 0xe0000
    buffer_load_dwordx4 v24, s[16:19], s28 offen lds
    s_add_u32 m0, s27, 0x10000
    s_mov_b32 s28, 0x100000
    buffer_load_dwordx4 v24, s[16:19], s28 offen lds
    s_add_u32 m0, s27, 0x11000
    s_mov_b32 s28, 0x120000
    buffer_load_dwordx4 v24, s[16:19], s28 offen lds
    s_add_u32 m0, s27, 0x12000
    s_mov_b32 s28, 0x140000
    buffer_load_dwordx4 v24, s[16:19], s28 offen lds
    s_add_u32 m0, s27, 0x13000
    s_mov_b32 s28, 0x160000
    buffer_load_dwordx4 v24, s[16:19], s28 offen lds
    s_add_u32 m0, s27, 0x14000
    s_mov_b32 s28, 0x180000
    buffer_load_dwordx4 v24, s[16:19], s28 offen lds
    s_add_u32 m0, s27, 0x15000
    s_mov_b32 s28, 0x1a0000
    buffer_load_dwordx4 v24, s[16:19], s28 offen lds
    s_add_u32 m0, s27, 0x16000
    s_mov_b32 s28, 0x1c0000
    buffer_load_dwordx4 v24, s[16:19], s28 offen lds
    s_add_u32 m0, s27, 0x17000
    s_mov_b32 s28, 0x1e0000
    buffer_load_dwordx4 v24, s[16:19], s28 offen lds
    s_waitcnt vmcnt(16)
    s_barrier
    v_xor_b32 v9, 0x0, v26
    v_add_u32 v9, 0x10000, v9
    ds_read_b64_tr_b16 a[16:17], v9 offset:32768
    ds_read_b64_tr_b16 a[18:19], v9 offset:33280
    ds_read_b64_tr_b16 a[20:21], v9 offset:40960
    ds_read_b64_tr_b16 a[22:23], v9 offset:41472
    v_xor_b32 v9, 0x20, v26
    v_add_u32 v9, 0x10000, v9
    ds_read_b64_tr_b16 a[24:25], v9 offset:32768
    ds_read_b64_tr_b16 a[26:27], v9 offset:33280
    ds_read_b64_tr_b16 a[28:29], v9 offset:40960
    ds_read_b64_tr_b16 a[30:31], v9 offset:41472
    v_xor_b32 v9, 0x4000, v26
    v_add_u32 v9, 0x10000, v9
    ds_read_b64_tr_b16 a[48:49], v9 offset:32768
    ds_read_b64_tr_b16 a[50:51], v9 offset:33280
    ds_read_b64_tr_b16 a[52:53], v9 offset:40960
    ds_read_b64_tr_b16 a[54:55], v9 offset:41472
    v_xor_b32 v9, 0x4020, v26
    v_add_u32 v9, 0x10000, v9
    ds_read_b64_tr_b16 a[56:57], v9 offset:32768
    ds_read_b64_tr_b16 a[58:59], v9 offset:33280
    ds_read_b64_tr_b16 a[60:61], v9 offset:40960
    ds_read_b64_tr_b16 a[62:63], v9 offset:41472
    v_xor_b32 v9, 0x8000, v26
    v_add_u32 v9, 0x10000, v9
    ds_read_b64_tr_b16 a[80:81], v9 offset:32768
    ds_read_b64_tr_b16 a[82:83], v9 offset:33280
    ds_read_b64_tr_b16 a[84:85], v9 offset:40960
    ds_read_b64_tr_b16 a[86:87], v9 offset:41472
    v_xor_b32 v9, 0x8020, v26
    v_add_u32 v9, 0x10000, v9
    ds_read_b64_tr_b16 a[88:89], v9 offset:32768
    ds_read_b64_tr_b16 a[90:91], v9 offset:33280
    ds_read_b64_tr_b16 a[92:93], v9 offset:40960
    ds_read_b64_tr_b16 a[94:95], v9 offset:41472
    v_xor_b32 v9, 0xc000, v26
    v_add_u32 v9, 0x10000, v9
    ds_read_b64_tr_b16 a[112:113], v9 offset:32768
    ds_read_b64_tr_b16 a[114:115], v9 offset:33280
    ds_read_b64_tr_b16 a[116:117], v9 offset:40960
    ds_read_b64_tr_b16 a[118:119], v9 offset:41472
    v_xor_b32 v9, 0xc020, v26
    v_add_u32 v9, 0x10000, v9
    ds_read_b64_tr_b16 a[120:121], v9 offset:32768
    ds_read_b64_tr_b16 a[122:123], v9 offset:33280
    ds_read_b64_tr_b16 a[124:125], v9 offset:40960
    ds_read_b64_tr_b16 a[126:127], v9 offset:41472
    s_waitcnt lgkmcnt(0)
    s_barrier
    s_add_u32 m0, s27, 0x18000
    s_mov_b32 s28, 0x200000
    buffer_load_dwordx4 v24, s[16:19], s28 offen lds
    s_add_u32 m0, s27, 0x19000
    s_mov_b32 s28, 0x220000
    buffer_load_dwordx4 v24, s[16:19], s28 offen lds
    s_add_u32 m0, s27, 0x1a000
    s_mov_b32 s28, 0x240000
    buffer_load_dwordx4 v24, s[16:19], s28 offen lds
    s_add_u32 m0, s27, 0x1b000
    s_mov_b32 s28, 0x260000
    buffer_load_dwordx4 v24, s[16:19], s28 offen lds
    s_add_u32 m0, s27, 0x1c000
    s_mov_b32 s28, 0x280000
    buffer_load_dwordx4 v24, s[16:19], s28 offen lds
    s_add_u32 m0, s27, 0x1d000
    s_mov_b32 s28, 0x2a0000
    buffer_load_dwordx4 v24, s[16:19], s28 offen lds
    s_add_u32 m0, s27, 0x1e000
    s_mov_b32 s28, 0x2c0000
    buffer_load_dwordx4 v24, s[16:19], s28 offen lds
    s_add_u32 m0, s27, 0x1f000
    s_mov_b32 s28, 0x2e0000
    buffer_load_dwordx4 v24, s[16:19], s28 offen lds
    s_add_u32 m0, s27, 0x20000
    s_mov_b32 s28, 0x300000
    buffer_load_dwordx4 v24, s[16:19], s28 offen lds
    s_add_u32 m0, s27, 0x21000
    s_mov_b32 s28, 0x320000
    buffer_load_dwordx4 v24, s[16:19], s28 offen lds
    s_add_u32 m0, s27, 0x22000
    s_mov_b32 s28, 0x340000
    buffer_load_dwordx4 v24, s[16:19], s28 offen lds
    s_add_u32 m0, s27, 0x23000
    s_mov_b32 s28, 0x360000
    buffer_load_dwordx4 v24, s[16:19], s28 offen lds
    s_add_u32 m0, s27, 0x24000
    s_mov_b32 s28, 0x380000
    buffer_load_dwordx4 v24, s[16:19], s28 offen lds
    s_add_u32 m0, s27, 0x25000
    s_mov_b32 s28, 0x3a0000
    buffer_load_dwordx4 v24, s[16:19], s28 offen lds
    s_add_u32 m0, s27, 0x26000
    s_mov_b32 s28, 0x3c0000
    buffer_load_dwordx4 v24, s[16:19], s28 offen lds
    s_add_u32 m0, s27, 0x27000
    s_mov_b32 s28, 0x3e0000
    buffer_load_dwordx4 v24, s[16:19], s28 offen lds
    s_waitcnt vmcnt(16)
    s_barrier
    v_xor_b32 v9, 0x0, v26
    v_add_u32 v9, 0x0, v9
    ds_read_b64_tr_b16 a[128:129], v9 offset:32768
    ds_read_b64_tr_b16 a[130:131], v9 offset:33280
    ds_read_b64_tr_b16 a[132:133], v9 offset:40960
    ds_read_b64_tr_b16 a[134:135], v9 offset:41472
    v_xor_b32 v9, 0x20, v26
    v_add_u32 v9, 0x0, v9
    ds_read_b64_tr_b16 a[136:137], v9 offset:32768
    ds_read_b64_tr_b16 a[138:139], v9 offset:33280
    ds_read_b64_tr_b16 a[140:141], v9 offset:40960
    ds_read_b64_tr_b16 a[142:143], v9 offset:41472
    v_xor_b32 v9, 0x4000, v26
    v_add_u32 v9, 0x0, v9
    ds_read_b64_tr_b16 a[160:161], v9 offset:32768
    ds_read_b64_tr_b16 a[162:163], v9 offset:33280
    ds_read_b64_tr_b16 a[164:165], v9 offset:40960
    ds_read_b64_tr_b16 a[166:167], v9 offset:41472
    v_xor_b32 v9, 0x4020, v26
    v_add_u32 v9, 0x0, v9
    ds_read_b64_tr_b16 a[168:169], v9 offset:32768
    ds_read_b64_tr_b16 a[170:171], v9 offset:33280
    ds_read_b64_tr_b16 a[172:173], v9 offset:40960
    ds_read_b64_tr_b16 a[174:175], v9 offset:41472
    v_xor_b32 v9, 0x8000, v26
    v_add_u32 v9, 0x0, v9
    ds_read_b64_tr_b16 a[192:193], v9 offset:32768
    ds_read_b64_tr_b16 a[194:195], v9 offset:33280
    ds_read_b64_tr_b16 a[196:197], v9 offset:40960
    ds_read_b64_tr_b16 a[198:199], v9 offset:41472
    v_xor_b32 v9, 0x8020, v26
    v_add_u32 v9, 0x0, v9
    ds_read_b64_tr_b16 a[200:201], v9 offset:32768
    ds_read_b64_tr_b16 a[202:203], v9 offset:33280
    ds_read_b64_tr_b16 a[204:205], v9 offset:40960
    ds_read_b64_tr_b16 a[206:207], v9 offset:41472
    v_xor_b32 v9, 0xc000, v26
    v_add_u32 v9, 0x0, v9
    ds_read_b64_tr_b16 a[224:225], v9 offset:32768
    ds_read_b64_tr_b16 a[226:227], v9 offset:33280
    ds_read_b64_tr_b16 a[228:229], v9 offset:40960
    ds_read_b64_tr_b16 a[230:231], v9 offset:41472
    v_xor_b32 v9, 0xc020, v26
    v_add_u32 v9, 0x0, v9
    ds_read_b64_tr_b16 a[232:233], v9 offset:32768
    ds_read_b64_tr_b16 a[234:235], v9 offset:33280
    ds_read_b64_tr_b16 a[236:237], v9 offset:40960
    ds_read_b64_tr_b16 a[238:239], v9 offset:41472
    s_waitcnt lgkmcnt(0)
    s_barrier
    s_mov_b32 s12, s72
    s_and_b32 s13, s73, 0xffff
    s_mov_b32 s14, 0x400000
    s_mov_b32 s15, 0x00020000
    s_add_u32 m0, s27, 0x8000
    s_mov_b32 s28, 0x0
    buffer_load_dwordx4 v24, s[12:15], s28 offen lds
    s_add_u32 m0, s27, 0x9000
    s_mov_b32 s28, 0x20000
    buffer_load_dwordx4 v24, s[12:15], s28 offen lds
    s_add_u32 m0, s27, 0xa000
    s_mov_b32 s28, 0x40000
    buffer_load_dwordx4 v24, s[12:15], s28 offen lds
    s_add_u32 m0, s27, 0xb000
    s_mov_b32 s28, 0x60000
    buffer_load_dwordx4 v24, s[12:15], s28 offen lds
    s_add_u32 m0, s27, 0xc000
    s_mov_b32 s28, 0x80000
    buffer_load_dwordx4 v24, s[12:15], s28 offen lds
    s_add_u32 m0, s27, 0xd000
    s_mov_b32 s28, 0xa0000
    buffer_load_dwordx4 v24, s[12:15], s28 offen lds
    s_add_u32 m0, s27, 0xe000
    s_mov_b32 s28, 0xc0000
    buffer_load_dwordx4 v24, s[12:15], s28 offen lds
    s_add_u32 m0, s27, 0xf000
    s_mov_b32 s28, 0xe0000
    buffer_load_dwordx4 v24, s[12:15], s28 offen lds
    s_add_u32 m0, s27, 0x10000
    s_mov_b32 s28, 0x100000
    buffer_load_dwordx4 v24, s[12:15], s28 offen lds
    s_add_u32 m0, s27, 0x11000
    s_mov_b32 s28, 0x120000
    buffer_load_dwordx4 v24, s[12:15], s28 offen lds
    s_add_u32 m0, s27, 0x12000
    s_mov_b32 s28, 0x140000
    buffer_load_dwordx4 v24, s[12:15], s28 offen lds
    s_add_u32 m0, s27, 0x13000
    s_mov_b32 s28, 0x160000
    buffer_load_dwordx4 v24, s[12:15], s28 offen lds
    s_add_u32 m0, s27, 0x14000
    s_mov_b32 s28, 0x180000
    buffer_load_dwordx4 v24, s[12:15], s28 offen lds
    s_add_u32 m0, s27, 0x15000
    s_mov_b32 s28, 0x1a0000
    buffer_load_dwordx4 v24, s[12:15], s28 offen lds
    s_add_u32 m0, s27, 0x16000
    s_mov_b32 s28, 0x1c0000
    buffer_load_dwordx4 v24, s[12:15], s28 offen lds
    s_add_u32 m0, s27, 0x17000
    s_mov_b32 s28, 0x1e0000
    buffer_load_dwordx4 v24, s[12:15], s28 offen lds
    s_waitcnt vmcnt(16)
    s_barrier
    v_xor_b32 v9, 0x0, v26
    v_add_u32 v9, 0x10000, v9
    ds_read_b64_tr_b16 a[144:145], v9 offset:32768
    ds_read_b64_tr_b16 a[146:147], v9 offset:33280
    ds_read_b64_tr_b16 a[148:149], v9 offset:40960
    ds_read_b64_tr_b16 a[150:151], v9 offset:41472
    v_xor_b32 v9, 0x20, v26
    v_add_u32 v9, 0x10000, v9
    ds_read_b64_tr_b16 a[152:153], v9 offset:32768
    ds_read_b64_tr_b16 a[154:155], v9 offset:33280
    ds_read_b64_tr_b16 a[156:157], v9 offset:40960
    ds_read_b64_tr_b16 a[158:159], v9 offset:41472
    v_xor_b32 v9, 0x4000, v26
    v_add_u32 v9, 0x10000, v9
    ds_read_b64_tr_b16 a[176:177], v9 offset:32768
    ds_read_b64_tr_b16 a[178:179], v9 offset:33280
    ds_read_b64_tr_b16 a[180:181], v9 offset:40960
    ds_read_b64_tr_b16 a[182:183], v9 offset:41472
    v_xor_b32 v9, 0x4020, v26
    v_add_u32 v9, 0x10000, v9
    ds_read_b64_tr_b16 a[184:185], v9 offset:32768
    ds_read_b64_tr_b16 a[186:187], v9 offset:33280
    ds_read_b64_tr_b16 a[188:189], v9 offset:40960
    ds_read_b64_tr_b16 a[190:191], v9 offset:41472
    v_xor_b32 v9, 0x8000, v26
    v_add_u32 v9, 0x10000, v9
    ds_read_b64_tr_b16 a[208:209], v9 offset:32768
    ds_read_b64_tr_b16 a[210:211], v9 offset:33280
    ds_read_b64_tr_b16 a[212:213], v9 offset:40960
    ds_read_b64_tr_b16 a[214:215], v9 offset:41472
    v_xor_b32 v9, 0x8020, v26
    v_add_u32 v9, 0x10000, v9
    ds_read_b64_tr_b16 a[216:217], v9 offset:32768
    ds_read_b64_tr_b16 a[218:219], v9 offset:33280
    ds_read_b64_tr_b16 a[220:221], v9 offset:40960
    ds_read_b64_tr_b16 a[222:223], v9 offset:41472
    v_xor_b32 v9, 0xc000, v26
    v_add_u32 v9, 0x10000, v9
    ds_read_b64_tr_b16 a[240:241], v9 offset:32768
    ds_read_b64_tr_b16 a[242:243], v9 offset:33280
    ds_read_b64_tr_b16 a[244:245], v9 offset:40960
    ds_read_b64_tr_b16 a[246:247], v9 offset:41472
    v_xor_b32 v9, 0xc020, v26
    v_add_u32 v9, 0x10000, v9
    ds_read_b64_tr_b16 a[248:249], v9 offset:32768
    ds_read_b64_tr_b16 a[250:251], v9 offset:33280
    ds_read_b64_tr_b16 a[252:253], v9 offset:40960
    ds_read_b64_tr_b16 a[254:255], v9 offset:41472
    s_waitcnt lgkmcnt(0)
    s_barrier
    s_add_u32 m0, s27, 0x18000
    s_mov_b32 s28, 0x200000
    buffer_load_dwordx4 v24, s[12:15], s28 offen lds
    s_add_u32 m0, s27, 0x19000
    s_mov_b32 s28, 0x220000
    buffer_load_dwordx4 v24, s[12:15], s28 offen lds
    s_add_u32 m0, s27, 0x1a000
    s_mov_b32 s28, 0x240000
    buffer_load_dwordx4 v24, s[12:15], s28 offen lds
    s_add_u32 m0, s27, 0x1b000
    s_mov_b32 s28, 0x260000
    buffer_load_dwordx4 v24, s[12:15], s28 offen lds
    s_add_u32 m0, s27, 0x1c000
    s_mov_b32 s28, 0x280000
    buffer_load_dwordx4 v24, s[12:15], s28 offen lds
    s_add_u32 m0, s27, 0x1d000
    s_mov_b32 s28, 0x2a0000
    buffer_load_dwordx4 v24, s[12:15], s28 offen lds
    s_add_u32 m0, s27, 0x1e000
    s_mov_b32 s28, 0x2c0000
    buffer_load_dwordx4 v24, s[12:15], s28 offen lds
    s_add_u32 m0, s27, 0x1f000
    s_mov_b32 s28, 0x2e0000
    buffer_load_dwordx4 v24, s[12:15], s28 offen lds
    s_add_u32 m0, s27, 0x20000
    s_mov_b32 s28, 0x300000
    buffer_load_dwordx4 v24, s[12:15], s28 offen lds
    s_add_u32 m0, s27, 0x21000
    s_mov_b32 s28, 0x320000
    buffer_load_dwordx4 v24, s[12:15], s28 offen lds
    s_add_u32 m0, s27, 0x22000
    s_mov_b32 s28, 0x340000
    buffer_load_dwordx4 v24, s[12:15], s28 offen lds
    s_add_u32 m0, s27, 0x23000
    s_mov_b32 s28, 0x360000
    buffer_load_dwordx4 v24, s[12:15], s28 offen lds
    s_add_u32 m0, s27, 0x24000
    s_mov_b32 s28, 0x380000
    buffer_load_dwordx4 v24, s[12:15], s28 offen lds
    s_add_u32 m0, s27, 0x25000
    s_mov_b32 s28, 0x3a0000
    buffer_load_dwordx4 v24, s[12:15], s28 offen lds
    s_add_u32 m0, s27, 0x26000
    s_mov_b32 s28, 0x3c0000
    buffer_load_dwordx4 v24, s[12:15], s28 offen lds
    s_add_u32 m0, s27, 0x27000
    s_mov_b32 s28, 0x3e0000
    buffer_load_dwordx4 v24, s[12:15], s28 offen lds
    s_waitcnt vmcnt(16)
    s_barrier
    v_xor_b32 v9, 0x0, v26
    v_add_u32 v9, 0x0, v9
    ds_read_b64_tr_b16 v[48:49], v9 offset:32768
    ds_read_b64_tr_b16 v[50:51], v9 offset:33280
    ds_read_b64_tr_b16 v[52:53], v9 offset:40960
    ds_read_b64_tr_b16 v[54:55], v9 offset:41472
    v_xor_b32 v9, 0x20, v26
    v_add_u32 v9, 0x0, v9
    ds_read_b64_tr_b16 v[56:57], v9 offset:32768
    ds_read_b64_tr_b16 v[58:59], v9 offset:33280
    ds_read_b64_tr_b16 v[60:61], v9 offset:40960
    ds_read_b64_tr_b16 v[62:63], v9 offset:41472
    v_xor_b32 v9, 0x4000, v26
    v_add_u32 v9, 0x0, v9
    ds_read_b64_tr_b16 v[64:65], v9 offset:32768
    ds_read_b64_tr_b16 v[66:67], v9 offset:33280
    ds_read_b64_tr_b16 v[68:69], v9 offset:40960
    ds_read_b64_tr_b16 v[70:71], v9 offset:41472
    v_xor_b32 v9, 0x4020, v26
    v_add_u32 v9, 0x0, v9
    ds_read_b64_tr_b16 v[72:73], v9 offset:32768
    ds_read_b64_tr_b16 v[74:75], v9 offset:33280
    ds_read_b64_tr_b16 v[76:77], v9 offset:40960
    ds_read_b64_tr_b16 v[78:79], v9 offset:41472
    v_xor_b32 v9, 0x8000, v26
    v_add_u32 v9, 0x0, v9
    ds_read_b64_tr_b16 v[80:81], v9 offset:32768
    ds_read_b64_tr_b16 v[82:83], v9 offset:33280
    ds_read_b64_tr_b16 v[84:85], v9 offset:40960
    ds_read_b64_tr_b16 v[86:87], v9 offset:41472
    v_xor_b32 v9, 0x8020, v26
    v_add_u32 v9, 0x0, v9
    ds_read_b64_tr_b16 v[88:89], v9 offset:32768
    ds_read_b64_tr_b16 v[90:91], v9 offset:33280
    ds_read_b64_tr_b16 v[92:93], v9 offset:40960
    ds_read_b64_tr_b16 v[94:95], v9 offset:41472
    v_xor_b32 v9, 0xc000, v26
    v_add_u32 v9, 0x0, v9
    ds_read_b64_tr_b16 v[96:97], v9 offset:32768
    ds_read_b64_tr_b16 v[98:99], v9 offset:33280
    ds_read_b64_tr_b16 v[100:101], v9 offset:40960
    ds_read_b64_tr_b16 v[102:103], v9 offset:41472
    v_xor_b32 v9, 0xc020, v26
    v_add_u32 v9, 0x0, v9
    ds_read_b64_tr_b16 v[104:105], v9 offset:32768
    ds_read_b64_tr_b16 v[106:107], v9 offset:33280
    ds_read_b64_tr_b16 v[108:109], v9 offset:40960
    ds_read_b64_tr_b16 v[110:111], v9 offset:41472
    s_waitcnt lgkmcnt(0)
    s_barrier
    ds_write_b128 v3, v[48:51] offset:0
    ds_write_b128 v3, v[52:55] offset:1024
    ds_write_b128 v3, v[56:59] offset:2048
    ds_write_b128 v3, v[60:63] offset:3072
    ds_write_b128 v3, v[64:67] offset:4096
    ds_write_b128 v3, v[68:71] offset:5120
    ds_write_b128 v3, v[72:75] offset:6144
    ds_write_b128 v3, v[76:79] offset:7168
    ds_write_b128 v3, v[80:83] offset:8192
    ds_write_b128 v3, v[84:87] offset:9216
    ds_write_b128 v3, v[88:91] offset:10240
    ds_write_b128 v3, v[92:95] offset:11264
    ds_write_b128 v3, v[96:99] offset:12288
    ds_write_b128 v3, v[100:103] offset:13312
    ds_write_b128 v3, v[104:107] offset:14336
    ds_write_b128 v3, v[108:111] offset:15360
    s_waitcnt lgkmcnt(0)
    s_barrier
    s_waitcnt vmcnt(0)
    s_barrier
    v_mov_b32 v29, 36
    v_lshrrev_b32 v43, 2, v0
    s_lshl_b32 s49, s24, 8
    s_add_u32 s49, s49, 0x50000
    buffer_load_dword v28, v29, s[8:11], 0 offen sc0 sc1
    buffer_load_dword v43, v43, s[4:7], s49 offen sc0 sc1
    v_xor_b32 v9, 0x0, v26
    v_add_u32 v9, 0x10000, v9
    ds_read_b64_tr_b16 v[48:49], v9 offset:32768
    ds_read_b64_tr_b16 v[50:51], v9 offset:33280
    ds_read_b64_tr_b16 v[52:53], v9 offset:40960
    ds_read_b64_tr_b16 v[54:55], v9 offset:41472
    v_xor_b32 v9, 0x20, v26
    v_add_u32 v9, 0x10000, v9
    ds_read_b64_tr_b16 v[56:57], v9 offset:32768
    ds_read_b64_tr_b16 v[58:59], v9 offset:33280
    ds_read_b64_tr_b16 v[60:61], v9 offset:40960
    ds_read_b64_tr_b16 v[62:63], v9 offset:41472
    v_xor_b32 v9, 0x4000, v26
    v_add_u32 v9, 0x10000, v9
    ds_read_b64_tr_b16 v[64:65], v9 offset:32768
    ds_read_b64_tr_b16 v[66:67], v9 offset:33280
    ds_read_b64_tr_b16 v[68:69], v9 offset:40960
    ds_read_b64_tr_b16 v[70:71], v9 offset:41472
    v_xor_b32 v9, 0x4020, v26
    v_add_u32 v9, 0x10000, v9
    ds_read_b64_tr_b16 v[72:73], v9 offset:32768
    ds_read_b64_tr_b16 v[74:75], v9 offset:33280
    ds_read_b64_tr_b16 v[76:77], v9 offset:40960
    ds_read_b64_tr_b16 v[78:79], v9 offset:41472
    v_xor_b32 v9, 0x8000, v26
    v_add_u32 v9, 0x10000, v9
    ds_read_b64_tr_b16 v[80:81], v9 offset:32768
    ds_read_b64_tr_b16 v[82:83], v9 offset:33280
    ds_read_b64_tr_b16 v[84:85], v9 offset:40960
    ds_read_b64_tr_b16 v[86:87], v9 offset:41472
    v_xor_b32 v9, 0x8020, v26
    v_add_u32 v9, 0x10000, v9
    ds_read_b64_tr_b16 v[88:89], v9 offset:32768
    ds_read_b64_tr_b16 v[90:91], v9 offset:33280
    ds_read_b64_tr_b16 v[92:93], v9 offset:40960
    ds_read_b64_tr_b16 v[94:95], v9 offset:41472
    v_xor_b32 v9, 0xc000, v26
    v_add_u32 v9, 0x10000, v9
    ds_read_b64_tr_b16 v[96:97], v9 offset:32768
    ds_read_b64_tr_b16 v[98:99], v9 offset:33280
    ds_read_b64_tr_b16 v[100:101], v9 offset:40960
    ds_read_b64_tr_b16 v[102:103], v9 offset:41472
    v_xor_b32 v9, 0xc020, v26
    v_add_u32 v9, 0x10000, v9
    ds_read_b64_tr_b16 v[104:105], v9 offset:32768
    ds_read_b64_tr_b16 v[106:107], v9 offset:33280
    ds_read_b64_tr_b16 v[108:109], v9 offset:40960
    ds_read_b64_tr_b16 v[110:111], v9 offset:41472
    s_waitcnt lgkmcnt(0)
    s_barrier
    ds_write_b128 v4, v[48:51] offset:0
    ds_write_b128 v4, v[52:55] offset:1024
    ds_write_b128 v4, v[56:59] offset:2048
    ds_write_b128 v4, v[60:63] offset:3072
    ds_write_b128 v4, v[64:67] offset:4096
    ds_write_b128 v4, v[68:71] offset:5120
    ds_write_b128 v4, v[72:75] offset:6144
    ds_write_b128 v4, v[76:79] offset:7168
    ds_write_b128 v4, v[80:83] offset:8192
    ds_write_b128 v4, v[84:87] offset:9216
    ds_write_b128 v4, v[88:91] offset:10240
    ds_write_b128 v4, v[92:95] offset:11264
    ds_write_b128 v4, v[96:99] offset:12288
    ds_write_b128 v4, v[100:103] offset:13312
    ds_write_b128 v4, v[104:107] offset:14336
    ds_write_b128 v4, v[108:111] offset:15360
    s_waitcnt lgkmcnt(0)
    s_barrier
    s_mov_b32 s12, s66
    s_and_b32 s13, s67, 0xffff
    s_mov_b32 s14, 0x2000
    s_mov_b32 s15, 0x00020000
    v_bfe_u32 v60, v0, 4, 3
    v_lshlrev_b32 v60, 10, v60
    v_lshrrev_b32 v61, 8, v0
    v_lshl_add_u32 v60, v61, 5, v60
    v_bfe_u32 v61, v0, 7, 1
    v_lshl_add_u32 v9, v61, 4, v60
    s_lshl_b32 s28, s20, 7
    buffer_load_dwordx4 v[44:47], v9, s[12:15], s28 offen
    buffer_load_dwordx4 v[48:51], v9, s[12:15], s28 offen offset:512
    s_mov_b32 s47, 0
    s_waitcnt vmcnt(2)
    v_cmp_eq_u32 s[40:41], s23, v43
    s_branch L_hb1
L_hb:
    buffer_load_dword v28, v29, s[8:11], 0 offen sc0 sc1
    s_add_u32 s47, s47, 1
    s_cmp_gt_u32 s47, 200000
    s_cbranch_scc1 L_end
    s_waitcnt vmcnt(0)
L_hb1:
    v_readfirstlane_b32 s28, v28
    s_and_b32 s29, s28, 0xffff
    s_cmp_lt_u32 s29, 32
    s_cbranch_scc1 L_hb
    s_lshr_b32 s48, s28, 16
    s_mov_b32 s33, 0
    s_mov_b32 s31, 0
    s_mov_b32 s34, 0x3e0293ee
    s_mov_b32 s35, 0x3e0293ee
    s_mul_i32 s45, s24, 0x180000
    s_add_u32 s45, s45, 0x200000
    s_mov_b32 s46, 0x100000
    s_cmp_lg_u32 s48, 0
    s_cbranch_scc1 L_hsm1
L_hsm0:
    s_add_u32 s32, s27, 0x2000
    s_mov_b32 s47, 0
L_flam0:
    s_bitcmp1_b64 s[40:41], 0
    s_cbranch_scc1 L_foam0
    v_lshrrev_b32 v9, 2, v0
    buffer_load_dword v9, v9, s[4:7], s49 offen sc0 sc1
    s_add_u32 s47, s47, 1
    s_cmp_gt_u32 s47, 200000
    s_cbranch_scc1 L_end
    s_waitcnt vmcnt(0)
    v_cmp_eq_u32 s[40:41], s23, v9
    s_nop 1
    s_branch L_flam0
L_foam0:
    s_mov_b32 s47, 0
L_flc1m0:
    s_bitcmp1_b64 s[40:41], 1
    s_cbranch_scc1 L_foc1m0
    v_lshrrev_b32 v9, 2, v0
    buffer_load_dword v9, v9, s[4:7], s49 offen sc0 sc1
    s_add_u32 s47, s47, 1
    s_cmp_gt_u32 s47, 200000
    s_cbranch_scc1 L_end
    s_waitcnt vmcnt(0)
    v_cmp_eq_u32 s[40:41], s23, v9
    s_nop 1
    s_branch L_flc1m0
L_foc1m0:
    s_mov_b32 s47, 0
L_flc2m0:
    s_bitcmp1_b64 s[40:41], 2
    s_cbranch_scc1 L_foc2m0
    v_lshrrev_b32 v9, 2, v0
    buffer_load_dword v9, v9, s[4:7], s49 offen sc0 sc1
    s_add_u32 s47, s47, 1
    s_cmp_gt_u32 s47, 200000
    s_cbranch_scc1 L_end
    s_waitcnt vmcnt(0)
    v_cmp_eq_u32 s[40:41], s23, v9
    s_nop 1
    s_branch L_flc2m0
L_foc2m0:
    buffer_load_dwordx4 v[76:79], v2, s[4:7], s45 offen sc1
    s_add_u32 s28, s45, 0x1000
    buffer_load_dwordx4 v[80:83], v2, s[4:7], s28 offen sc1
    s_add_u32 s28, s45, s32
    buffer_load_dwordx4 v[84:87], v2, s[4:7], s28 offen sc1
    buffer_load_dwordx2 v[90:91], v2, s[4:7], s28 offen offset:1024 sc1
    buffer_load_dwordx2 v[88:89], v2, s[4:7], s28 offen offset:1032 sc1
    buffer_load_dwordx2 v[90:91], v2, s[4:7], s28 offen offset:1024 sc1
    buffer_load_dwordx2 v[88:89], v2, s[4:7], s28 offen offset:1032 sc1
    s_sub_u32 s28, s20, 1
    s_lshl_b32 s100, s28, 13
    s_add_u32 s100, s100, s45
    s_cmp_lt_u32 s28, 2
    s_cselect_b64 vcc, -1, 0
    v_lshlrev_b32 v60, 2, v0
    v_cndmask_b32 v8, v8, v60, vcc
    s_add_u32 s45, s45, 24576
    s_add_u32 s28, s31, 2
    s_min_u32 s28, s28, 63
    s_mov_b32 s47, 0
L_fldm0:
    s_bitcmp1_b64 s[40:41], s28
    s_cbranch_scc1 L_fodm0
    v_lshrrev_b32 v9, 2, v0
    buffer_load_dword v9, v9, s[4:7], s49 offen sc0 sc1
    s_add_u32 s47, s47, 1
    s_cmp_gt_u32 s47, 200000
    s_cbranch_scc1 L_end
    s_waitcnt vmcnt(0)
    v_cmp_eq_u32 s[40:41], s23, v9
    s_nop 1
    s_branch L_fldm0
L_fodm0:
    s_mul_i32 s29, s28, 24576
    s_add_u32 s29, s29, s100
    ds_read_b128 v[96:99], v3 offset:0
    ds_read_b128 v[100:103], v3 offset:1024
    ds_read_b128 v[104:107], v3 offset:2048
    ds_read_b128 v[108:111], v3 offset:3072
    ds_read_b128 v[112:115], v4 offset:0
    ds_read_b128 v[116:119], v4 offset:1024
    ds_read_b128 v[120:123], v4 offset:2048
    ds_read_b128 v[124:127], v4 offset:3072
    v_mov_b32 v20, 0
    v_mov_b32 v21, 0
    v_mov_b32 v22, 0
    v_mov_b32 v23, 0
    v_mov_b32 v24, 0
    v_mov_b32 v25, 0
    v_mov_b32 v26, 0
    v_mov_b32 v27, 0
    v_mov_b32 v28, 0
    v_mov_b32 v29, 0
    v_mov_b32 v30, 0
    v_mov_b32 v31, 0
    v_mov_b32 v32, 0
    v_mov_b32 v33, 0
    v_mov_b32 v34, 0
    v_mov_b32 v35, 0
    v_mov_b32 v36, 0
    v_mov_b32 v37, 0
    v_mov_b32 v38, 0
    v_mov_b32 v39, 0
    v_mov_b32 v40, 0
    v_mov_b32 v41, 0
    v_mov_b32 v42, 0
    v_mov_b32 v43, 0
    s_mov_b64 s[98:99], vcc
    s_mov_b64 s[96:97], 0
    s_mov_b64 vcc, 0
    v_xor_b32 v73, 0x400, v2
    v_xor_b32 v74, 0x800, v2
    v_xor_b32 v75, 0xc00, v2
    s_waitcnt vmcnt(7) lgkmcnt(0)
    ds_write_b128 v2, v[44:47] offset:0
    ds_write_b128 v2, v[48:51] offset:4096
    s_branch L_stepm0
L_rt2m0:
    buffer_load_dwordx4 v[44:47], v2, s[4:7], s38 offen sc1
    buffer_load_dwordx4 v[48:51], v2, s[4:7], s39 offen sc1
    s_add_u32 s47, s47, 1
    s_cmp_gt_u32 s47, 200000
    s_cbranch_scc1 L_end
    s_nop 7
    v_mov_b32 v20, 0
    v_mov_b32 v21, 0
    v_mov_b32 v22, 0
    v_mov_b32 v23, 0
    v_mov_b32 v24, 0
    v_mov_b32 v25, 0
    v_mov_b32 v26, 0
    v_mov_b32 v27, 0
    s_branch L_p2m0
L_topm0:
    s_mov_b32 s47, 0
    s_nop 15
    s_nop 15
    s_nop 6
    buffer_load_dwordx4 v[44:47], v2, s[4:7], s38 offen sc1
    buffer_load_dwordx4 v[48:51], v2, s[4:7], s39 offen sc1
    v_xor_b32 v73, 0x400, v2
    v_xor_b32 v74, 0x800, v2
    v_xor_b32 v75, 0xc00, v2
L_p2m0:
    s_waitcnt vmcnt(1) lgkmcnt(0)
    ds_write_b128 v2, v[44:47] offset:0
    v_bitop3_b32 v52, v44, v46, s33 bitop3:0x7e
    s_waitcnt vmcnt(0)
    ds_write_b128 v2, v[48:51] offset:4096
    v_bitop3_b32 v53, v48, v50, s33 bitop3:0x7e
    v_bitop3_b32 v52, v52, v53, 1 bitop3:0xa8
    v_cmp_ne_u32 vcc, 0, v52
L_stepm0:
    v_smfmac_f32_16x16x64_bf16 v[20:23], v[44:47], a[0:7], v1
    v_smfmac_f32_16x16x64_bf16 v[24:27], v[44:47], a[8:15], v1
    s_cbranch_vccnz L_rt2m0
    s_xor_b32 s33, s33, 1
    s_waitcnt lgkmcnt(0)
    s_barrier
    ds_read_b128 v[52:55], v73 offset:0
    v_smfmac_f32_16x16x64_bf16 v[20:23], v[48:51], a[16:23], v1
    ds_read_b128 v[56:59], v73 offset:4096
    v_smfmac_f32_16x16x64_bf16 v[24:27], v[48:51], a[24:31], v1
    ds_read_b128 v[60:63], v74 offset:0
    v_smfmac_f32_16x16x64_bf16 v[28:31], v[44:47], a[128:135], v1
    ds_read_b128 v[64:67], v74 offset:4096
    v_smfmac_f32_16x16x64_bf16 v[32:35], v[44:47], a[136:143], v1
    ds_read_b128 v[68:71], v75 offset:0
    v_smfmac_f32_16x16x64_bf16 v[28:31], v[48:51], a[144:151], v1
    ds_read_b128 v[72:75], v75 offset:4096
    v_smfmac_f32_16x16x64_bf16 v[32:35], v[48:51], a[152:159], v1
    v_smfmac_f32_16x16x64_bf16 v[36:39], v[44:47], v[96:103], v1
    ds_read_b128 v[96:99], v3 offset:4096
    v_smfmac_f32_16x16x64_bf16 v[40:43], v[44:47], v[104:111], v1
    ds_read_b128 v[100:103], v3 offset:5120
    v_smfmac_f32_16x16x64_bf16 v[36:39], v[48:51], v[112:119], v1
    ds_read_b128 v[104:107], v3 offset:6144
    v_smfmac_f32_16x16x64_bf16 v[40:43], v[48:51], v[120:127], v1
    ds_read_b128 v[108:111], v3 offset:7168
    s_waitcnt lgkmcnt(9)
    v_smfmac_f32_16x16x64_bf16 v[20:23], v[52:55], a[32:39], v1
    ds_read_b128 v[112:115], v4 offset:4096
    v_smfmac_f32_16x16x64_bf16 v[24:27], v[52:55], a[40:47], v1
    ds_read_b128 v[116:119], v4 offset:5120
    s_waitcnt lgkmcnt(10)
    v_smfmac_f32_16x16x64_bf16 v[20:23], v[56:59], a[48:55], v1
    ds_read_b128 v[120:123], v4 offset:6144
    v_smfmac_f32_16x16x64_bf16 v[24:27], v[56:59], a[56:63], v1
    ds_read_b128 v[124:127], v4 offset:7168
    s_waitcnt lgkmcnt(11)
    v_smfmac_f32_16x16x64_bf16 v[20:23], v[60:63], a[64:71], v1
    v_smfmac_f32_16x16x64_bf16 v[24:27], v[60:63], a[72:79], v1
    s_waitcnt lgkmcnt(10)
    v_smfmac_f32_16x16x64_bf16 v[20:23], v[64:67], a[80:87], v1
    v_lshlrev_b32 v9, 1, v8
    v_smfmac_f32_16x16x64_bf16 v[24:27], v[64:67], a[88:95], v1
    s_mov_b64 exec, s[96:97]
    buffer_store_dwordx4 v[92:95], v9, s[4:7], s46 offen sc0 sc1
    s_mov_b64 exec, -1
    s_waitcnt lgkmcnt(9)
    v_smfmac_f32_16x16x64_bf16 v[20:23], v[68:71], a[96:103], v1
    s_mov_b64 exec, s[98:99]
    buffer_load_dword v16, v9, s[4:7], s29 offen sc0 sc1
    s_mov_b64 exec, -1
    v_smfmac_f32_16x16x64_bf16 v[24:27], v[68:71], a[104:111], v1
    v_xor_b32 v48, 0x400, v2
    s_waitcnt lgkmcnt(8)
    v_smfmac_f32_16x16x64_bf16 v[20:23], v[72:75], a[112:119], v1
    v_xor_b32 v49, 0x800, v2
    v_smfmac_f32_16x16x64_bf16 v[24:27], v[72:75], a[120:127], v1
    v_xor_b32 v50, 0xc00, v2
    s_waitcnt lgkmcnt(6)
    v_smfmac_f32_16x16x64_bf16 v[36:39], v[52:55], v[96:103], v1
    ds_read_b128 v[96:99], v3 offset:8192
    v_cvt_pk_bf16_f32 v92, v20, v21
    v_smfmac_f32_16x16x64_bf16 v[28:31], v[52:55], a[160:167], v1
    ds_read_b128 v[100:103], v3 offset:9216
    v_cvt_pk_bf16_f32 v93, v22, v23
    s_waitcnt lgkmcnt(6)
    v_smfmac_f32_16x16x64_bf16 v[40:43], v[52:55], v[104:111], v1
    ds_read_b128 v[104:107], v3 offset:10240
    v_cvt_pk_bf16_f32 v94, v24, v25
    v_mfma_f32_16x16x16_bf16 v[20:23], v[92:93], v[10:11], 0
    v_cvt_pk_bf16_f32 v95, v26, v27
    v_smfmac_f32_16x16x64_bf16 v[32:35], v[52:55], a[168:175], v1
    ds_read_b128 v[108:111], v3 offset:11264
    v_mfma_f32_16x16x16_bf16 v[24:27], v[94:95], v[10:11], 0
    v_cvt_pk_bf16_f32 v92, v20, v21
    v_cvt_pk_bf16_f32 v93, v22, v23
    v_smfmac_f32_16x16x64_bf16 v[28:31], v[56:59], a[176:183], v1
    s_waitcnt lgkmcnt(6)
    v_smfmac_f32_16x16x64_bf16 v[36:39], v[56:59], v[112:119], v1
    ds_read_b128 v[112:115], v4 offset:8192
    v_cvt_pk_bf16_f32 v94, v24, v25
    v_smfmac_f32_16x16x64_bf16 v[32:35], v[56:59], a[184:191], v1
    ds_read_b128 v[116:119], v4 offset:9216
    v_cvt_pk_bf16_f32 v95, v26, v27
    s_waitcnt lgkmcnt(6)
    v_smfmac_f32_16x16x64_bf16 v[40:43], v[56:59], v[120:127], v1
    ds_read_b128 v[120:123], v4 offset:10240
    s_waitcnt vmcnt(5)
    v_mfma_f32_16x16x32_bf16 v[20:23], v[76:79], v[92:95], 0
    v_mfma_f32_16x16x32_bf16 v[24:27], v[80:83], v[92:95], 0
    v_smfmac_f32_16x16x64_bf16 v[28:31], v[60:63], a[192:199], v1
    ds_read_b128 v[124:127], v4 offset:11264
    s_mov_b64 exec, s[42:43]
    ds_write_b128 v2, v[20:23] offset:8192
    s_mov_b64 exec, -1
    v_smfmac_f32_16x16x64_bf16 v[32:35], v[60:63], a[200:207], v1
    s_not_b64 exec, s[42:43]
    ds_write_b128 v2, v[24:27] offset:8192
    s_mov_b64 exec, -1
    s_waitcnt lgkmcnt(8)
    v_smfmac_f32_16x16x64_bf16 v[36:39], v[60:63], v[96:103], v1
    ds_read_b128 v[96:99], v3 offset:12288
    v_smfmac_f32_16x16x64_bf16 v[28:31], v[64:67], a[208:215], v1
    ds_read_b128 v[100:103], v3 offset:13312
    buffer_load_dwordx4 v[76:79], v2, s[4:7], s45 offen sc1
    s_waitcnt lgkmcnt(8)
    v_smfmac_f32_16x16x64_bf16 v[40:43], v[60:63], v[104:111], v1
    ds_read_b128 v[104:107], v3 offset:14336
    v_smfmac_f32_16x16x64_bf16 v[32:35], v[64:67], a[216:223], v1
    ds_read_b128 v[108:111], v3 offset:15360
    s_waitcnt lgkmcnt(4)
    s_barrier
    ds_read_b128 v[20:23], v0 offset:8192
    v_smfmac_f32_16x16x64_bf16 v[36:39], v[64:67], v[112:119], v1
    ds_read_b128 v[24:27], v0 offset:9216
    ds_read_b128 v[52:55], v0 offset:10240
    v_smfmac_f32_16x16x64_bf16 v[28:31], v[68:71], a[224:231], v1
    ds_read_b128 v[56:59], v0 offset:11264
    ds_read_b128 v[112:115], v4 offset:12288
    v_smfmac_f32_16x16x64_bf16 v[40:43], v[64:67], v[120:127], v1
    ds_read_b128 v[116:119], v4 offset:13312
    ds_read_b128 v[120:123], v4 offset:14336
    v_smfmac_f32_16x16x64_bf16 v[32:35], v[68:71], a[232:239], v1
    ds_read_b128 v[124:127], v4 offset:15360
    s_add_u32 s28, s45, 0x1000
    buffer_load_dwordx4 v[80:83], v2, s[4:7], s28 offen sc1
    v_smfmac_f32_16x16x64_bf16 v[28:31], v[72:75], a[240:247], v1
    s_waitcnt lgkmcnt(6)
    v_add_f32 v20, v20, v24
    v_smfmac_f32_16x16x64_bf16 v[32:35], v[72:75], a[248:255], v1
    v_add_f32 v21, v21, v25
    v_smfmac_f32_16x16x64_bf16 v[36:39], v[68:71], v[96:103], v1
    v_cvt_pk_bf16_f32 v44, v28, v29
    v_cvt_pk_bf16_f32 v45, v30, v31
    v_smfmac_f32_16x16x64_bf16 v[40:43], v[68:71], v[104:111], v1
    v_cvt_pk_bf16_f32 v46, v32, v33
    v_cvt_pk_bf16_f32 v47, v34, v35
    v_mfma_f32_16x16x16_bf16 v[28:31], v[44:45], v[10:11], 0
    v_add_f32 v22, v22, v26
    v_add_f32 v23, v23, v27
    s_waitcnt lgkmcnt(4)
    v_mfma_f32_16x16x16_bf16 v[32:35], v[46:47], v[10:11], 0
    v_add_f32 v52, v52, v56
    v_add_f32 v53, v53, v57
    v_add_f32 v54, v54, v58
    v_add_f32 v55, v55, v59
    v_cvt_pk_bf16_f32 v44, v28, v29
    v_cvt_pk_bf16_f32 v45, v30, v31
    v_add_f32 v20, v20, v52
    v_add_f32 v21, v21, v53
    v_cvt_pk_bf16_f32 v46, v32, v33
    v_cvt_pk_bf16_f32 v47, v34, v35
    v_add_f32 v22, v22, v54
    v_add_f32 v23, v23, v55
    v_mfma_f32_16x16x32_bf16 v[28:31], v[44:47], v[92:95], 0
    v_max3_f32 v52, v20, v21, v22
    v_max_f32 v52, v52, v23
    v_mov_b32 v96, 0
    v_mov_b32 v97, 0
    v_max_f32_dpp v53, v52, v52 row_ror:8 row_mask:0xf bank_mask:0xf
    s_waitcnt lgkmcnt(2)
    v_smfmac_f32_16x16x64_bf16 v[36:39], v[72:75], v[112:119], v1
    ds_write_b128 v2, v[28:31] offset:12288
    v_max_f32_dpp v54, v52, v52 row_ror:8 row_mask:0xf bank_mask:0xf
    v_mov_b32 v94, 0
    v_mov_b32 v95, 0
    v_permlane32_swap_b32 v53, v54
    v_max_f32 v52, v53, v54
    v_max_f32 v55, v53, v54
    v_mov_b32 v92, 0
    v_mov_b32 v93, 0
    v_permlane16_swap_b32 v52, v55
    v_max_f32 v51, v52, v55
    v_mul_f32 v9, s34, v51
    v_pk_fma_f32 v[20:21], v[20:21], s[34:35], v[8:9] op_sel:[0,0,1] op_sel_hi:[1,1,1] neg_lo:[0,0,1] neg_hi:[0,0,1]
    v_pk_fma_f32 v[22:23], v[22:23], s[34:35], v[8:9] op_sel:[0,0,1] op_sel_hi:[1,1,1] neg_lo:[0,0,1] neg_hi:[0,0,1]
    s_waitcnt lgkmcnt(0)
    s_barrier
    v_smfmac_f32_16x16x64_bf16 v[40:43], v[72:75], v[120:127], v1
    ds_read_b128 v[32:35], v48 offset:12288
    ds_read_b128 v[52:55], v49 offset:12288
    ds_read_b128 v[56:59], v50 offset:12288
    v_exp_f32 v20, v20
    v_exp_f32 v21, v21
    v_exp_f32 v22, v22
    v_exp_f32 v23, v23
    v_cvt_pk_bf16_f32 v24, v20, v21
    v_cvt_pk_bf16_f32 v25, v22, v23
    v_cvt_pk_bf16_f32 v36, v36, v37
    v_cvt_pk_bf16_f32 v37, v38, v39
    v_mov_b32_dpp v26, v24 row_ror:8 row_mask:0xf bank_mask:0xf
    v_mov_b32_dpp v27, v25 row_ror:8 row_mask:0xf bank_mask:0xf
    v_cvt_pk_bf16_f32 v38, v40, v41
    v_cvt_pk_bf16_f32 v39, v42, v43
    s_waitcnt vmcnt(4)
    s_waitcnt lgkmcnt(2)
    v_pk_add_f32 v[28:29], v[28:29], v[32:33]
    v_pk_add_f32 v[30:31], v[30:31], v[34:35]
    s_waitcnt lgkmcnt(0)
    v_pk_add_f32 v[52:53], v[52:53], v[56:57]
    v_pk_add_f32 v[54:55], v[54:55], v[58:59]
    v_pk_add_f32 v[28:29], v[28:29], v[52:53]
    v_pk_add_f32 v[30:31], v[30:31], v[54:55]
    v_mfma_f32_16x16x32_bf16 v[112:115], v[84:87], v[24:27], 0
    v_max3_f32 v44, v28, v29, v30
    v_max_f32 v45, v44, v31
    v_max_f32 v46, v44, v31
    v_mfma_f32_16x16x32_bf16 v[116:119], v[88:91], v[24:27], 0
    v_mov_b32 v98, 0
    v_permlane16_swap_b32 v45, v46
    v_max3_f32 v44, v45, v46, v51
    v_mul_f32 v44, s34, v44
    v_mfma_f32_16x16x32_bf16 v[20:23], v[12:15], v[24:27], 0
    v_fma_f32 v28, v28, s34, -v44
    v_fma_f32 v29, v29, s34, -v44
    v_fma_f32 v30, v30, s34, -v44
    v_fma_f32 v31, v31, s34, -v44
    v_sub_f32 v44, v9, v44
    v_exp_f32 v28, v28
    v_exp_f32 v29, v29
    v_exp_f32 v30, v30
    v_exp_f32 v31, v31
    v_exp_f32 v44, v44
    s_mov_b64 exec, s[42:43]
    v_cvt_pk_bf16_f32 v92, v28, v29
    v_cvt_pk_bf16_f32 v93, v30, v31
    v_pk_mul_f32 v[112:113], v[112:113], v[44:45] op_sel:[0,0] op_sel_hi:[1,0]
    v_pk_mul_f32 v[114:115], v[114:115], v[44:45] op_sel:[0,0] op_sel_hi:[1,0]
    s_not_b64 exec, exec
    v_cvt_pk_bf16_f32 v94, v28, v29
    v_cvt_pk_bf16_f32 v95, v30, v31
    v_pk_mul_f32 v[112:113], v[116:117], v[44:45] op_sel:[0,0] op_sel_hi:[1,0]
    v_pk_mul_f32 v[114:115], v[118:119], v[44:45] op_sel:[0,0] op_sel_hi:[1,0]
    s_mov_b64 exec, -1
    v_mul_f32 v44, v20, v44
    v_mfma_f32_16x16x32_bf16 v[20:23], v[12:15], v[92:95], 0
    v_mov_b32 v99, 0
    v_mov_b32 v100, 0
    v_mfma_f32_16x16x32_bf16 v[112:115], v[36:39], v[92:95], v[112:115]
    v_mov_b32_dpp v9, v6 row_ror:8 row_mask:0xf bank_mask:0xf
    v_mov_b32 v101, 0
    v_mov_b32 v102, 0
    v_mov_b32 v103, 0
    v_fma_f32 v44, v44, 2.0, v20
    v_rcp_f32 v44, v44
    v_mov_b32 v104, 0
    v_pk_mul_f32 v[112:113], v[112:113], v[44:45] op_sel:[0,0] op_sel_hi:[1,0]
    v_pk_mul_f32 v[114:115], v[114:115], v[44:45] op_sel:[0,0] op_sel_hi:[1,0]
    v_cvt_pk_bf16_f32 v112, v112, v113
    v_cvt_pk_bf16_f32 v113, v114, v115
    ds_write_b64 v5, v[112:113] offset:16384
    s_add_u32 s28, s45, s32
    buffer_load_dwordx4 v[84:87], v2, s[4:7], s28 offen sc1
    v_mov_b32 v105, 0
    v_mov_b32 v106, 0
    v_mov_b32 v107, 0
    s_waitcnt lgkmcnt(0)
    s_barrier
    ds_read_b128 v[112:115], v6 offset:16384
    ds_read_b128 v[116:119], v9 offset:16384
    ds_read_b128 v[120:123], v6 offset:16512
    ds_read_b128 v[124:127], v9 offset:16512
    v_mov_b32 v108, 0
    v_mov_b32 v109, 0
    buffer_load_dwordx2 v[90:91], v2, s[4:7], s28 offen offset:1024 sc1
    v_mov_b32 v110, 0
    v_mov_b32 v111, 0
    buffer_load_dwordx2 v[88:89], v2, s[4:7], s28 offen offset:1032 sc1
    s_waitcnt lgkmcnt(3)
    v_smfmac_f32_16x16x64_bf16 v[96:99], v[112:115], v[128:135], v1
    v_smfmac_f32_16x16x64_bf16 v[100:103], v[112:115], v[160:167], v1
    s_waitcnt lgkmcnt(2)
    v_smfmac_f32_16x16x64_bf16 v[96:99], v[116:119], v[136:143], v1
    v_smfmac_f32_16x16x64_bf16 v[100:103], v[116:119], v[168:175], v1
    s_waitcnt lgkmcnt(1)
    v_smfmac_f32_16x16x64_bf16 v[96:99], v[120:123], v[144:151], v1
    v_smfmac_f32_16x16x64_bf16 v[100:103], v[120:123], v[176:183], v1
    s_waitcnt lgkmcnt(0)
    v_smfmac_f32_16x16x64_bf16 v[96:99], v[124:127], v[152:159], v1
    v_smfmac_f32_16x16x64_bf16 v[100:103], v[124:127], v[184:191], v1
    v_smfmac_f32_16x16x64_bf16 v[104:107], v[112:115], v[192:199], v1
    v_smfmac_f32_16x16x64_bf16 v[108:111], v[112:115], v[224:231], v1
    v_cvt_pk_bf16_f32 v44, v96, v97
    v_smfmac_f32_16x16x64_bf16 v[104:107], v[116:119], v[200:207], v1
    v_cvt_pk_bf16_f32 v45, v98, v99
    v_smfmac_f32_16x16x64_bf16 v[108:111], v[116:119], v[232:239], v1
    v_cvt_pk_bf16_f32 v46, v100, v101
    v_smfmac_f32_16x16x64_bf16 v[104:107], v[120:123], v[208:215], v1
    v_cvt_pk_bf16_f32 v47, v102, v103
    v_smfmac_f32_16x16x64_bf16 v[108:111], v[120:123], v[240:247], v1
    v_and_or_b32 v44, v44, -2, s33
    buffer_store_dwordx4 v[44:47], v7, s[4:7], 0 offen
    v_smfmac_f32_16x16x64_bf16 v[104:107], v[124:127], v[216:223], v1
    v_smfmac_f32_16x16x64_bf16 v[108:111], v[124:127], v[248:255], v1
    s_nop 2
    v_cvt_pk_bf16_f32 v48, v104, v105
    v_cvt_pk_bf16_f32 v49, v106, v107
    v_and_or_b32 v48, v48, -2, s33
    s_nop 0
    v_cvt_pk_bf16_f32 v50, v108, v109
    v_cvt_pk_bf16_f32 v51, v110, v111
    buffer_store_dwordx4 v[48:51], v7, s[4:7], s44 offen
    ds_read_b128 v[96:99], v3 offset:0
    ds_read_b128 v[100:103], v3 offset:1024
    ds_read_b128 v[104:107], v3 offset:2048
    ds_read_b128 v[108:111], v3 offset:3072
    ds_read_b128 v[112:115], v4 offset:0
    ds_read_b128 v[116:119], v4 offset:1024
    ds_read_b128 v[120:123], v4 offset:2048
    ds_read_b128 v[124:127], v4 offset:3072
    v_mov_b32 v20, 0
    v_mov_b32 v21, 0
    v_mov_b32 v22, 0
    v_mov_b32 v23, 0
    v_mov_b32 v24, 0
    v_mov_b32 v25, 0
    v_mov_b32 v26, 0
    v_mov_b32 v27, 0
    v_mov_b32 v28, 0
    v_mov_b32 v29, 0
    v_mov_b32 v30, 0
    v_mov_b32 v31, 0
    v_mov_b32 v32, 0
    v_mov_b32 v33, 0
    v_mov_b32 v34, 0
    v_mov_b32 v35, 0
    v_mov_b32 v36, 0
    v_mov_b32 v37, 0
    v_mov_b32 v38, 0
    v_mov_b32 v39, 0
    v_mov_b32 v40, 0
    v_mov_b32 v41, 0
    v_mov_b32 v42, 0
    v_mov_b32 v43, 0
    s_add_u32 s31, s31, 1
    s_cmp_eq_u32 s20, 0
    s_cbranch_scc1 L_redm0
    s_add_u32 s45, s45, 24576
    s_add_u32 s28, s31, 2
    s_min_u32 s28, s28, 63
    s_mov_b32 s47, 0
L_flbm0:
    s_bitcmp1_b64 s[40:41], s28
    s_cbranch_scc1 L_fobm0
    v_lshrrev_b32 v9, 2, v0
    buffer_load_dword v9, v9, s[4:7], s49 offen sc0 sc1
    s_add_u32 s47, s47, 1
    s_cmp_gt_u32 s47, 200000
    s_cbranch_scc1 L_end
    s_waitcnt vmcnt(0)
    v_cmp_eq_u32 s[40:41], s23, v9
    s_nop 1
    s_branch L_flbm0
L_fobm0:
    s_mul_i32 s29, s28, 24576
    s_add_u32 s29, s29, s100
    s_branch L_b4m0
L_redm0:
    s_add_u32 s45, s45, 24576
    s_mov_b64 s[96:97], s[42:43]
    s_mov_b32 s47, 0
    s_add_u32 s46, s46, 0x4000
    s_nop 15
    s_nop 11
    s_bitcmp1_b32 s24, 2
    s_cbranch_scc0 L_rm0
    s_nop 15
    s_nop 5
L_rm0:
    buffer_load_dwordx4 v[44:47], v0, s[4:7], s36 offen offset:0 sc1
    buffer_load_dwordx4 v[48:51], v0, s[4:7], s36 offen offset:1024 sc1
    buffer_load_dwordx4 v[52:55], v0, s[4:7], s36 offen offset:2048 sc1
    buffer_load_dwordx4 v[56:59], v0, s[4:7], s36 offen offset:3072 sc1
    buffer_load_dwordx4 v[60:63], v0, s[4:7], s37 offen offset:0 sc1
    buffer_load_dwordx4 v[64:67], v0, s[4:7], s37 offen offset:1024 sc1
    buffer_load_dwordx4 v[68:71], v0, s[4:7], s37 offen offset:2048 sc1
    buffer_load_dwordx4 v[72:75], v0, s[4:7], s37 offen offset:3072 sc1
    s_add_u32 s47, s47, 1
    s_cmp_gt_u32 s47, 200000
    s_cbranch_scc1 L_end
    s_waitcnt vmcnt(7)
    v_mfma_f32_16x16x32_bf16 v[92:95], v[44:47], v[16:19], 0
    s_waitcnt vmcnt(6)
    v_mfma_f32_16x16x32_bf16 v[92:95], v[48:51], v[16:19], v[92:95]
    s_waitcnt vmcnt(5)
    v_mfma_f32_16x16x32_bf16 v[92:95], v[52:55], v[16:19], v[92:95]
    s_waitcnt vmcnt(4)
    v_mfma_f32_16x16x32_bf16 v[92:95], v[56:59], v[16:19], v[92:95]
    s_waitcnt vmcnt(3)
    v_mfma_f32_16x16x32_bf16 v[92:95], v[60:63], v[16:19], v[92:95]
    s_waitcnt vmcnt(2)
    v_mfma_f32_16x16x32_bf16 v[92:95], v[64:67], v[16:19], v[92:95]
    s_waitcnt vmcnt(1)
    v_mfma_f32_16x16x32_bf16 v[92:95], v[68:71], v[16:19], v[92:95]
    s_waitcnt vmcnt(0)
    v_mfma_f32_16x16x32_bf16 v[92:95], v[72:75], v[16:19], v[92:95]
    v_bitop3_b32 v45, v44, v48, s33 bitop3:0x7e
    v_bitop3_b32 v46, v52, v56, s33 bitop3:0x7e
    v_bitop3_b32 v47, v60, v64, s33 bitop3:0x7e
    v_bitop3_b32 v49, v68, v72, s33 bitop3:0x7e
    v_or3_b32 v9, v45, v46, v47
    v_bitop3_b32 v9, v9, v49, 1 bitop3:0xa8
    v_cmp_ne_u32 vcc, 0, v9
    s_nop 0
    v_cvt_pk_bf16_f32 v92, v92, v93
    v_cvt_pk_bf16_f32 v93, v94, v95
    v_and_or_b32 v92, v92, -2, s33
    s_cbranch_vccnz L_rm0
    s_mov_b64 exec, s[42:43]
    buffer_store_dwordx2 v[92:93], v8, s[4:7], s38 offen
    s_mov_b64 exec, -1
    v_mov_b32 v94, s23
    v_mov_b32 v95, s23
    s_bitcmp1_b32 s24, 2
    s_cbranch_scc1 L_b4m0
    s_nop 15
    s_nop 1
L_b4m0:
    s_barrier
    s_cmp_lg_u32 s31, 63
    s_cbranch_scc1 L_topm0
L_finm0:
    s_cmp_lg_u32 s20, 0
    s_cbranch_scc1 L_end
    v_lshlrev_b32 v9, 1, v8
    s_mov_b64 exec, s[42:43]
    buffer_store_dwordx4 v[92:95], v9, s[4:7], s46 offen sc0 sc1
    s_mov_b64 exec, -1
    s_branch L_end
L_hsm1:
    s_add_u32 s32, s27, 0x2000
    s_mov_b32 s47, 0
L_flam1:
    s_bitcmp1_b64 s[40:41], 0
    s_cbranch_scc1 L_foam1
    v_lshrrev_b32 v9, 2, v0
    buffer_load_dword v9, v9, s[4:7], s49 offen sc0 sc1
    s_add_u32 s47, s47, 1
    s_cmp_gt_u32 s47, 200000
    s_cbranch_scc1 L_end
    s_waitcnt vmcnt(0)
    v_cmp_eq_u32 s[40:41], s23, v9
    s_nop 1
    s_branch L_flam1
L_foam1:
    s_mov_b32 s47, 0
L_flc1m1:
    s_bitcmp1_b64 s[40:41], 1
    s_cbranch_scc1 L_foc1m1
    v_lshrrev_b32 v9, 2, v0
    buffer_load_dword v9, v9, s[4:7], s49 offen sc0 sc1
    s_add_u32 s47, s47, 1
    s_cmp_gt_u32 s47, 200000
    s_cbranch_scc1 L_end
    s_waitcnt vmcnt(0)
    v_cmp_eq_u32 s[40:41], s23, v9
    s_nop 1
    s_branch L_flc1m1
L_foc1m1:
    s_mov_b32 s47, 0
L_flc2m1:
    s_bitcmp1_b64 s[40:41], 2
    s_cbranch_scc1 L_foc2m1
    v_lshrrev_b32 v9, 2, v0
    buffer_load_dword v9, v9, s[4:7], s49 offen sc0 sc1
    s_add_u32 s47, s47, 1
    s_cmp_gt_u32 s47, 200000
    s_cbranch_scc1 L_end
    s_waitcnt vmcnt(0)
    v_cmp_eq_u32 s[40:41], s23, v9
    s_nop 1
    s_branch L_flc2m1
L_foc2m1:
    buffer_load_dwordx4 v[76:79], v2, s[4:7], s45 offen sc1
    s_add_u32 s28, s45, 0x1000
    buffer_load_dwordx4 v[80:83], v2, s[4:7], s28 offen sc1
    s_add_u32 s28, s45, s32
    buffer_load_dwordx4 v[84:87], v2, s[4:7], s28 offen sc1
    buffer_load_dwordx2 v[90:91], v2, s[4:7], s28 offen offset:1024 sc1
    buffer_load_dwordx2 v[88:89], v2, s[4:7], s28 offen offset:1032 sc1
    buffer_load_dwordx2 v[90:91], v2, s[4:7], s28 offen offset:1024 sc1
    buffer_load_dwordx2 v[88:89], v2, s[4:7], s28 offen offset:1032 sc1
    s_sub_u32 s28, s20, 1
    s_lshl_b32 s100, s28, 13
    s_add_u32 s100, s100, s45
    s_cmp_lt_u32 s28, 2
    s_cselect_b64 vcc, -1, 0
    v_lshlrev_b32 v60, 2, v0
    v_cndmask_b32 v8, v8, v60, vcc
    s_add_u32 s45, s45, 24576
    s_add_u32 s28, s31, 2
    s_min_u32 s28, s28, 63
    s_mov_b32 s47, 0
L_fldm1:
    s_bitcmp1_b64 s[40:41], s28
    s_cbranch_scc1 L_fodm1
    v_lshrrev_b32 v9, 2, v0
    buffer_load_dword v9, v9, s[4:7], s49 offen sc0 sc1
    s_add_u32 s47, s47, 1
    s_cmp_gt_u32 s47, 200000
    s_cbranch_scc1 L_end
    s_waitcnt vmcnt(0)
    v_cmp_eq_u32 s[40:41], s23, v9
    s_nop 1
    s_branch L_fldm1
L_fodm1:
    s_mul_i32 s29, s28, 24576
    s_add_u32 s29, s29, s100
    ds_read_b128 v[96:99], v3 offset:0
    ds_read_b128 v[100:103], v3 offset:1024
    ds_read_b128 v[104:107], v3 offset:2048
    ds_read_b128 v[108:111], v3 offset:3072
    ds_read_b128 v[112:115], v4 offset:0
    ds_read_b128 v[116:119], v4 offset:1024
    ds_read_b128 v[120:123], v4 offset:2048
    ds_read_b128 v[124:127], v4 offset:3072
    v_mov_b32 v20, 0
    v_mov_b32 v21, 0
    v_mov_b32 v22, 0
    v_mov_b32 v23, 0
    v_mov_b32 v24, 0
    v_mov_b32 v25, 0
    v_mov_b32 v26, 0
    v_mov_b32 v27, 0
    v_mov_b32 v28, 0
    v_mov_b32 v29, 0
    v_mov_b32 v30, 0
    v_mov_b32 v31, 0
    v_mov_b32 v32, 0
    v_mov_b32 v33, 0
    v_mov_b32 v34, 0
    v_mov_b32 v35, 0
    v_mov_b32 v36, 0
    v_mov_b32 v37, 0
    v_mov_b32 v38, 0
    v_mov_b32 v39, 0
    v_mov_b32 v40, 0
    v_mov_b32 v41, 0
    v_mov_b32 v42, 0
    v_mov_b32 v43, 0
    s_mov_b64 s[98:99], vcc
    s_mov_b64 s[96:97], 0
    s_mov_b64 vcc, 0
    v_xor_b32 v73, 0x400, v2
    v_xor_b32 v74, 0x800, v2
    v_xor_b32 v75, 0xc00, v2
    s_waitcnt vmcnt(7) lgkmcnt(0)
    ds_write_b128 v2, v[44:47] offset:0
    ds_write_b128 v2, v[48:51] offset:4096
    s_branch L_stepm1
L_rt2m1:
    buffer_load_dwordx4 v[44:47], v2, s[4:7], s38 offen sc1
    buffer_load_dwordx4 v[48:51], v2, s[4:7], s39 offen sc1
    s_add_u32 s47, s47, 1
    s_cmp_gt_u32 s47, 200000
    s_cbranch_scc1 L_end
    s_nop 7
    v_mov_b32 v20, 0
    v_mov_b32 v21, 0
    v_mov_b32 v22, 0
    v_mov_b32 v23, 0
    v_mov_b32 v24, 0
    v_mov_b32 v25, 0
    v_mov_b32 v26, 0
    v_mov_b32 v27, 0
    s_branch L_p2m1
L_topm1:
    s_mov_b32 s47, 0
    s_nop 15
    s_nop 15
    s_nop 6
    buffer_load_dwordx4 v[44:47], v2, s[4:7], s38 offen sc1
    buffer_load_dwordx4 v[48:51], v2, s[4:7], s39 offen sc1
    v_xor_b32 v73, 0x400, v2
    v_xor_b32 v74, 0x800, v2
    v_xor_b32 v75, 0xc00, v2
L_p2m1:
    s_waitcnt vmcnt(1) lgkmcnt(0)
    ds_write_b128 v2, v[44:47] offset:0
    v_bitop3_b32 v52, v44, v46, s33 bitop3:0x7e
    s_waitcnt vmcnt(0)
    ds_write_b128 v2, v[48:51] offset:4096
    v_bitop3_b32 v53, v48, v50, s33 bitop3:0x7e
    v_bitop3_b32 v52, v52, v53, 1 bitop3:0xa8
    v_cmp_ne_u32 vcc, 0, v52
L_stepm1:
    v_smfmac_f32_16x16x64_bf16 v[20:23], v[44:47], a[0:7], v1
    v_smfmac_f32_16x16x64_bf16 v[24:27], v[44:47], a[8:15], v1
    s_cbranch_vccnz L_rt2m1
    s_xor_b32 s33, s33, 1
    s_waitcnt lgkmcnt(0)
    s_barrier
    ds_read_b128 v[52:55], v73 offset:0
    v_smfmac_f32_16x16x64_bf16 v[20:23], v[48:51], a[16:23], v1
    ds_read_b128 v[56:59], v73 offset:4096
    v_smfmac_f32_16x16x64_bf16 v[24:27], v[48:51], a[24:31], v1
    ds_read_b128 v[60:63], v74 offset:0
    v_smfmac_f32_16x16x64_bf16 v[28:31], v[44:47], a[128:135], v1
    ds_read_b128 v[64:67], v74 offset:4096
    v_smfmac_f32_16x16x64_bf16 v[32:35], v[44:47], a[136:143], v1
    ds_read_b128 v[68:71], v75 offset:0
    v_smfmac_f32_16x16x64_bf16 v[28:31], v[48:51], a[144:151], v1
    ds_read_b128 v[72:75], v75 offset:4096
    v_smfmac_f32_16x16x64_bf16 v[32:35], v[48:51], a[152:159], v1
    v_smfmac_f32_16x16x64_bf16 v[36:39], v[44:47], v[96:103], v1
    ds_read_b128 v[96:99], v3 offset:4096
    v_smfmac_f32_16x16x64_bf16 v[40:43], v[44:47], v[104:111], v1
    ds_read_b128 v[100:103], v3 offset:5120
    v_smfmac_f32_16x16x64_bf16 v[36:39], v[48:51], v[112:119], v1
    ds_read_b128 v[104:107], v3 offset:6144
    v_smfmac_f32_16x16x64_bf16 v[40:43], v[48:51], v[120:127], v1
    ds_read_b128 v[108:111], v3 offset:7168
    s_waitcnt lgkmcnt(9)
    v_smfmac_f32_16x16x64_bf16 v[20:23], v[52:55], a[32:39], v1
    ds_read_b128 v[112:115], v4 offset:4096
    v_smfmac_f32_16x16x64_bf16 v[24:27], v[52:55], a[40:47], v1
    ds_read_b128 v[116:119], v4 offset:5120
    s_waitcnt lgkmcnt(10)
    v_smfmac_f32_16x16x64_bf16 v[20:23], v[56:59], a[48:55], v1
    ds_read_b128 v[120:123], v4 offset:6144
    v_smfmac_f32_16x16x64_bf16 v[24:27], v[56:59], a[56:63], v1
    ds_read_b128 v[124:127], v4 offset:7168
    s_waitcnt lgkmcnt(11)
    v_smfmac_f32_16x16x64_bf16 v[20:23], v[60:63], a[64:71], v1
    v_smfmac_f32_16x16x64_bf16 v[24:27], v[60:63], a[72:79], v1
    s_waitcnt lgkmcnt(10)
    v_smfmac_f32_16x16x64_bf16 v[20:23], v[64:67], a[80:87], v1
    v_lshlrev_b32 v9, 1, v8
    v_smfmac_f32_16x16x64_bf16 v[24:27], v[64:67], a[88:95], v1
    s_mov_b64 exec, s[96:97]
    buffer_store_dwordx4 v[92:95], v9, s[4:7], s46 offen sc0 sc1
    s_mov_b64 exec, -1
    s_waitcnt lgkmcnt(9)
    v_smfmac_f32_16x16x64_bf16 v[20:23], v[68:71], a[96:103], v1
    s_mov_b64 exec, s[98:99]
    buffer_load_dword v16, v9, s[4:7], s29 offen sc0 sc1
    s_mov_b64 exec, -1
    v_smfmac_f32_16x16x64_bf16 v[24:27], v[68:71], a[104:111], v1
    v_xor_b32 v48, 0x400, v2
    s_waitcnt lgkmcnt(8)
    v_smfmac_f32_16x16x64_bf16 v[20:23], v[72:75], a[112:119], v1
    v_xor_b32 v49, 0x800, v2
    v_smfmac_f32_16x16x64_bf16 v[24:27], v[72:75], a[120:127], v1
    v_xor_b32 v50, 0xc00, v2
    s_waitcnt lgkmcnt(6)
    v_smfmac_f32_16x16x64_bf16 v[36:39], v[52:55], v[96:103], v1
    ds_read_b128 v[96:99], v3 offset:8192
    v_cvt_pk_bf16_f32 v92, v20, v21
    v_smfmac_f32_16x16x64_bf16 v[28:31], v[52:55], a[160:167], v1
    ds_read_b128 v[100:103], v3 offset:9216
    v_cvt_pk_bf16_f32 v93, v22, v23
    s_waitcnt lgkmcnt(6)
    v_smfmac_f32_16x16x64_bf16 v[40:43], v[52:55], v[104:111], v1
    ds_read_b128 v[104:107], v3 offset:10240
    v_cvt_pk_bf16_f32 v94, v24, v25
    v_mfma_f32_16x16x16_bf16 v[20:23], v[92:93], v[10:11], 0
    v_cvt_pk_bf16_f32 v95, v26, v27
    v_smfmac_f32_16x16x64_bf16 v[32:35], v[52:55], a[168:175], v1
    ds_read_b128 v[108:111], v3 offset:11264
    v_mfma_f32_16x16x16_bf16 v[24:27], v[94:95], v[10:11], 0
    v_cvt_pk_bf16_f32 v92, v20, v21
    v_cvt_pk_bf16_f32 v93, v22, v23
    v_smfmac_f32_16x16x64_bf16 v[28:31], v[56:59], a[176:183], v1
    s_waitcnt lgkmcnt(6)
    v_smfmac_f32_16x16x64_bf16 v[36:39], v[56:59], v[112:119], v1
    ds_read_b128 v[112:115], v4 offset:8192
    v_cvt_pk_bf16_f32 v94, v24, v25
    v_smfmac_f32_16x16x64_bf16 v[32:35], v[56:59], a[184:191], v1
    ds_read_b128 v[116:119], v4 offset:9216
    v_cvt_pk_bf16_f32 v95, v26, v27
    s_waitcnt lgkmcnt(6)
    v_smfmac_f32_16x16x64_bf16 v[40:43], v[56:59], v[120:127], v1
    ds_read_b128 v[120:123], v4 offset:10240
    s_waitcnt vmcnt(5)
    v_mfma_f32_16x16x32_bf16 v[20:23], v[76:79], v[92:95], 0
    v_mfma_f32_16x16x32_bf16 v[24:27], v[80:83], v[92:95], 0
    v_smfmac_f32_16x16x64_bf16 v[28:31], v[60:63], a[192:199], v1
    ds_read_b128 v[124:127], v4 offset:11264
    s_mov_b64 exec, s[42:43]
    ds_write_b128 v2, v[20:23] offset:8192
    s_mov_b64 exec, -1
    v_smfmac_f32_16x16x64_bf16 v[32:35], v[60:63], a[200:207], v1
    s_not_b64 exec, s[42:43]
    ds_write_b128 v2, v[24:27] offset:8192
    s_mov_b64 exec, -1
    s_waitcnt lgkmcnt(8)
    v_smfmac_f32_16x16x64_bf16 v[36:39], v[60:63], v[96:103], v1
    ds_read_b128 v[96:99], v3 offset:12288
    v_smfmac_f32_16x16x64_bf16 v[28:31], v[64:67], a[208:215], v1
    ds_read_b128 v[100:103], v3 offset:13312
    buffer_load_dwordx4 v[76:79], v2, s[4:7], s45 offen sc1
    s_waitcnt lgkmcnt(8)
    v_smfmac_f32_16x16x64_bf16 v[40:43], v[60:63], v[104:111], v1
    ds_read_b128 v[104:107], v3 offset:14336
    v_smfmac_f32_16x16x64_bf16 v[32:35], v[64:67], a[216:223], v1
    ds_read_b128 v[108:111], v3 offset:15360
    s_waitcnt lgkmcnt(4)
    s_barrier
    ds_read_b128 v[20:23], v0 offset:8192
    v_smfmac_f32_16x16x64_bf16 v[36:39], v[64:67], v[112:119], v1
    ds_read_b128 v[24:27], v0 offset:9216
    ds_read_b128 v[52:55], v0 offset:10240
    v_smfmac_f32_16x16x64_bf16 v[28:31], v[68:71], a[224:231], v1
    ds_read_b128 v[56:59], v0 offset:11264
    ds_read_b128 v[112:115], v4 offset:12288
    v_smfmac_f32_16x16x64_bf16 v[40:43], v[64:67], v[120:127], v1
    ds_read_b128 v[116:119], v4 offset:13312
    ds_read_b128 v[120:123], v4 offset:14336
    v_smfmac_f32_16x16x64_bf16 v[32:35], v[68:71], a[232:239], v1
    ds_read_b128 v[124:127], v4 offset:15360
    s_add_u32 s28, s45, 0x1000
    buffer_load_dwordx4 v[80:83], v2, s[4:7], s28 offen sc1
    v_smfmac_f32_16x16x64_bf16 v[28:31], v[72:75], a[240:247], v1
    s_waitcnt lgkmcnt(6)
    v_add_f32 v20, v20, v24
    v_smfmac_f32_16x16x64_bf16 v[32:35], v[72:75], a[248:255], v1
    v_add_f32 v21, v21, v25
    v_smfmac_f32_16x16x64_bf16 v[36:39], v[68:71], v[96:103], v1
    v_cvt_pk_bf16_f32 v44, v28, v29
    v_cvt_pk_bf16_f32 v45, v30, v31
    v_smfmac_f32_16x16x64_bf16 v[40:43], v[68:71], v[104:111], v1
    v_cvt_pk_bf16_f32 v46, v32, v33
    v_cvt_pk_bf16_f32 v47, v34, v35
    v_mfma_f32_16x16x16_bf16 v[28:31], v[44:45], v[10:11], 0
    v_add_f32 v22, v22, v26
    v_add_f32 v23, v23, v27
    s_waitcnt lgkmcnt(4)
    v_mfma_f32_16x16x16_bf16 v[32:35], v[46:47], v[10:11], 0
    v_add_f32 v52, v52, v56
    v_add_f32 v53, v53, v57
    v_add_f32 v54, v54, v58
    v_add_f32 v55, v55, v59
    v_cvt_pk_bf16_f32 v44, v28, v29
    v_cvt_pk_bf16_f32 v45, v30, v31
    v_add_f32 v20, v20, v52
    v_add_f32 v21, v21, v53
    v_cvt_pk_bf16_f32 v46, v32, v33
    v_cvt_pk_bf16_f32 v47, v34, v35
    v_add_f32 v22, v22, v54
    v_add_f32 v23, v23, v55
    v_mfma_f32_16x16x32_bf16 v[28:31], v[44:47], v[92:95], 0
    v_max3_f32 v52, v20, v21, v22
    v_max_f32 v52, v52, v23
    v_mov_b32 v96, 0
    v_mov_b32 v97, 0
    v_max_f32_dpp v53, v52, v52 row_ror:8 row_mask:0xf bank_mask:0xf
    s_waitcnt lgkmcnt(2)
    v_smfmac_f32_16x16x64_bf16 v[36:39], v[72:75], v[112:119], v1
    ds_write_b128 v2, v[28:31] offset:12288
    v_max_f32_dpp v54, v52, v52 row_ror:8 row_mask:0xf bank_mask:0xf
    v_mov_b32 v94, 0
    v_mov_b32 v95, 0
    v_permlane32_swap_b32 v53, v54
    v_max_f32 v52, v53, v54
    v_max_f32 v55, v53, v54
    v_mov_b32 v92, 0
    v_mov_b32 v93, 0
    v_permlane16_swap_b32 v52, v55
    v_max_f32 v51, v52, v55
    v_mul_f32 v9, s34, v51
    v_pk_fma_f32 v[20:21], v[20:21], s[34:35], v[8:9] op_sel:[0,0,1] op_sel_hi:[1,1,1] neg_lo:[0,0,1] neg_hi:[0,0,1]
    v_pk_fma_f32 v[22:23], v[22:23], s[34:35], v[8:9] op_sel:[0,0,1] op_sel_hi:[1,1,1] neg_lo:[0,0,1] neg_hi:[0,0,1]
    s_waitcnt lgkmcnt(0)
    s_barrier
    v_smfmac_f32_16x16x64_bf16 v[40:43], v[72:75], v[120:127], v1
    ds_read_b128 v[32:35], v48 offset:12288
    ds_read_b128 v[52:55], v49 offset:12288
    ds_read_b128 v[56:59], v50 offset:12288
    v_exp_f32 v20, v20
    v_exp_f32 v21, v21
    v_exp_f32 v22, v22
    v_exp_f32 v23, v23
    v_cvt_pk_bf16_f32 v24, v20, v21
    v_cvt_pk_bf16_f32 v25, v22, v23
    v_cvt_pk_bf16_f32 v36, v36, v37
    v_cvt_pk_bf16_f32 v37, v38, v39
    v_mov_b32_dpp v26, v24 row_ror:8 row_mask:0xf bank_mask:0xf
    v_mov_b32_dpp v27, v25 row_ror:8 row_mask:0xf bank_mask:0xf
    v_cvt_pk_bf16_f32 v38, v40, v41
    v_cvt_pk_bf16_f32 v39, v42, v43
    s_waitcnt vmcnt(4)
    s_waitcnt lgkmcnt(2)
    v_pk_add_f32 v[28:29], v[28:29], v[32:33]
    v_pk_add_f32 v[30:31], v[30:31], v[34:35]
    s_waitcnt lgkmcnt(0)
    v_pk_add_f32 v[52:53], v[52:53], v[56:57]
    v_pk_add_f32 v[54:55], v[54:55], v[58:59]
    v_pk_add_f32 v[28:29], v[28:29], v[52:53]
    v_pk_add_f32 v[30:31], v[30:31], v[54:55]
    v_mfma_f32_16x16x32_bf16 v[112:115], v[84:87], v[24:27], 0
    v_max3_f32 v44, v28, v29, v30
    v_max_f32 v45, v44, v31
    v_max_f32 v46, v44, v31
    v_mfma_f32_16x16x32_bf16 v[116:119], v[88:91], v[24:27], 0
    v_mov_b32 v98, 0
    v_permlane16_swap_b32 v45, v46
    v_max3_f32 v44, v45, v46, v51
    v_mul_f32 v44, s34, v44
    v_mfma_f32_16x16x32_bf16 v[20:23], v[12:15], v[24:27], 0
    v_fma_f32 v28, v28, s34, -v44
    v_fma_f32 v29, v29, s34, -v44
    v_fma_f32 v30, v30, s34, -v44
    v_fma_f32 v31, v31, s34, -v44
    v_sub_f32 v44, v9, v44
    v_exp_f32 v28, v28
    v_exp_f32 v29, v29
    v_exp_f32 v30, v30
    v_exp_f32 v31, v31
    v_exp_f32 v44, v44
    s_mov_b64 exec, s[42:43]
    v_cvt_pk_bf16_f32 v92, v28, v29
    v_cvt_pk_bf16_f32 v93, v30, v31
    v_pk_mul_f32 v[112:113], v[112:113], v[44:45] op_sel:[0,0] op_sel_hi:[1,0]
    v_pk_mul_f32 v[114:115], v[114:115], v[44:45] op_sel:[0,0] op_sel_hi:[1,0]
    s_not_b64 exec, exec
    v_cvt_pk_bf16_f32 v94, v28, v29
    v_cvt_pk_bf16_f32 v95, v30, v31
    v_pk_mul_f32 v[112:113], v[116:117], v[44:45] op_sel:[0,0] op_sel_hi:[1,0]
    v_pk_mul_f32 v[114:115], v[118:119], v[44:45] op_sel:[0,0] op_sel_hi:[1,0]
    s_mov_b64 exec, -1
    v_mul_f32 v44, v20, v44
    v_mfma_f32_16x16x32_bf16 v[20:23], v[12:15], v[92:95], 0
    v_mov_b32 v99, 0
    v_mov_b32 v100, 0
    v_mfma_f32_16x16x32_bf16 v[112:115], v[36:39], v[92:95], v[112:115]
    v_mov_b32_dpp v9, v6 row_ror:8 row_mask:0xf bank_mask:0xf
    v_mov_b32 v101, 0
    v_mov_b32 v102, 0
    v_mov_b32 v103, 0
    v_fma_f32 v44, v44, 2.0, v20
    v_rcp_f32 v44, v44
    v_mov_b32 v104, 0
    v_pk_mul_f32 v[112:113], v[112:113], v[44:45] op_sel:[0,0] op_sel_hi:[1,0]
    v_pk_mul_f32 v[114:115], v[114:115], v[44:45] op_sel:[0,0] op_sel_hi:[1,0]
    v_cvt_pk_bf16_f32 v112, v112, v113
    v_cvt_pk_bf16_f32 v113, v114, v115
    ds_write_b64 v5, v[112:113] offset:16384
    s_add_u32 s28, s45, s32
    buffer_load_dwordx4 v[84:87], v2, s[4:7], s28 offen sc1
    v_mov_b32 v105, 0
    v_mov_b32 v106, 0
    v_mov_b32 v107, 0
    s_waitcnt lgkmcnt(0)
    s_barrier
    ds_read_b128 v[112:115], v6 offset:16384
    ds_read_b128 v[116:119], v9 offset:16384
    ds_read_b128 v[120:123], v6 offset:16512
    ds_read_b128 v[124:127], v9 offset:16512
    v_mov_b32 v108, 0
    v_mov_b32 v109, 0
    buffer_load_dwordx2 v[90:91], v2, s[4:7], s28 offen offset:1024 sc1
    v_mov_b32 v110, 0
    v_mov_b32 v111, 0
    buffer_load_dwordx2 v[88:89], v2, s[4:7], s28 offen offset:1032 sc1
    s_waitcnt lgkmcnt(3)
    v_smfmac_f32_16x16x64_bf16 v[96:99], v[112:115], v[128:135], v1
    v_smfmac_f32_16x16x64_bf16 v[100:103], v[112:115], v[160:167], v1
    s_waitcnt lgkmcnt(2)
    v_smfmac_f32_16x16x64_bf16 v[96:99], v[116:119], v[136:143], v1
    v_smfmac_f32_16x16x64_bf16 v[100:103], v[116:119], v[168:175], v1
    s_waitcnt lgkmcnt(1)
    v_smfmac_f32_16x16x64_bf16 v[96:99], v[120:123], v[144:151], v1
    v_smfmac_f32_16x16x64_bf16 v[100:103], v[120:123], v[176:183], v1
    s_waitcnt lgkmcnt(0)
    v_smfmac_f32_16x16x64_bf16 v[96:99], v[124:127], v[152:159], v1
    v_smfmac_f32_16x16x64_bf16 v[100:103], v[124:127], v[184:191], v1
    v_smfmac_f32_16x16x64_bf16 v[104:107], v[112:115], v[192:199], v1
    v_smfmac_f32_16x16x64_bf16 v[108:111], v[112:115], v[224:231], v1
    v_cvt_pk_bf16_f32 v44, v96, v97
    v_smfmac_f32_16x16x64_bf16 v[104:107], v[116:119], v[200:207], v1
    v_cvt_pk_bf16_f32 v45, v98, v99
    v_smfmac_f32_16x16x64_bf16 v[108:111], v[116:119], v[232:239], v1
    v_cvt_pk_bf16_f32 v46, v100, v101
    v_smfmac_f32_16x16x64_bf16 v[104:107], v[120:123], v[208:215], v1
    v_cvt_pk_bf16_f32 v47, v102, v103
    v_smfmac_f32_16x16x64_bf16 v[108:111], v[120:123], v[240:247], v1
    v_and_or_b32 v44, v44, -2, s33
    buffer_store_dwordx4 v[44:47], v7, s[4:7], 0 offen sc0 sc1
    v_smfmac_f32_16x16x64_bf16 v[104:107], v[124:127], v[216:223], v1
    v_smfmac_f32_16x16x64_bf16 v[108:111], v[124:127], v[248:255], v1
    s_nop 2
    v_cvt_pk_bf16_f32 v48, v104, v105
    v_cvt_pk_bf16_f32 v49, v106, v107
    v_and_or_b32 v48, v48, -2, s33
    s_nop 0
    v_cvt_pk_bf16_f32 v50, v108, v109
    v_cvt_pk_bf16_f32 v51, v110, v111
    buffer_store_dwordx4 v[48:51], v7, s[4:7], s44 offen sc0 sc1
    ds_read_b128 v[96:99], v3 offset:0
    ds_read_b128 v[100:103], v3 offset:1024
    ds_read_b128 v[104:107], v3 offset:2048
    ds_read_b128 v[108:111], v3 offset:3072
    ds_read_b128 v[112:115], v4 offset:0
    ds_read_b128 v[116:119], v4 offset:1024
    ds_read_b128 v[120:123], v4 offset:2048
    ds_read_b128 v[124:127], v4 offset:3072
    v_mov_b32 v20, 0
    v_mov_b32 v21, 0
    v_mov_b32 v22, 0
    v_mov_b32 v23, 0
    v_mov_b32 v24, 0
    v_mov_b32 v25, 0
    v_mov_b32 v26, 0
    v_mov_b32 v27, 0
    v_mov_b32 v28, 0
    v_mov_b32 v29, 0
    v_mov_b32 v30, 0
    v_mov_b32 v31, 0
    v_mov_b32 v32, 0
    v_mov_b32 v33, 0
    v_mov_b32 v34, 0
    v_mov_b32 v35, 0
    v_mov_b32 v36, 0
    v_mov_b32 v37, 0
    v_mov_b32 v38, 0
    v_mov_b32 v39, 0
    v_mov_b32 v40, 0
    v_mov_b32 v41, 0
    v_mov_b32 v42, 0
    v_mov_b32 v43, 0
    s_add_u32 s31, s31, 1
    s_cmp_eq_u32 s20, 0
    s_cbranch_scc1 L_redm1
    s_add_u32 s45, s45, 24576
    s_add_u32 s28, s31, 2
    s_min_u32 s28, s28, 63
    s_mov_b32 s47, 0
L_flbm1:
    s_bitcmp1_b64 s[40:41], s28
    s_cbranch_scc1 L_fobm1
    v_lshrrev_b32 v9, 2, v0
    buffer_load_dword v9, v9, s[4:7], s49 offen sc0 sc1
    s_add_u32 s47, s47, 1
    s_cmp_gt_u32 s47, 200000
    s_cbranch_scc1 L_end
    s_waitcnt vmcnt(0)
    v_cmp_eq_u32 s[40:41], s23, v9
    s_nop 1
    s_branch L_flbm1
L_fobm1:
    s_mul_i32 s29, s28, 24576
    s_add_u32 s29, s29, s100
    s_branch L_b4m1
L_redm1:
    s_add_u32 s45, s45, 24576
    s_mov_b64 s[96:97], s[42:43]
    s_mov_b32 s47, 0
    s_add_u32 s46, s46, 0x4000
    s_nop 15
    s_nop 11
    s_bitcmp1_b32 s24, 2
    s_cbranch_scc0 L_rm1
    s_nop 15
    s_nop 5
L_rm1:
    buffer_load_dwordx4 v[44:47], v0, s[4:7], s36 offen offset:0 sc1
    buffer_load_dwordx4 v[48:51], v0, s[4:7], s36 offen offset:1024 sc1
    buffer_load_dwordx4 v[52:55], v0, s[4:7], s36 offen offset:2048 sc1
    buffer_load_dwordx4 v[56:59], v0, s[4:7], s36 offen offset:3072 sc1
    buffer_load_dwordx4 v[60:63], v0, s[4:7], s37 offen offset:0 sc1
    buffer_load_dwordx4 v[64:67], v0, s[4:7], s37 offen offset:1024 sc1
    buffer_load_dwordx4 v[68:71], v0, s[4:7], s37 offen offset:2048 sc1
    buffer_load_dwordx4 v[72:75], v0, s[4:7], s37 offen offset:3072 sc1
    s_add_u32 s47, s47, 1
    s_cmp_gt_u32 s47, 200000
    s_cbranch_scc1 L_end
    s_waitcnt vmcnt(7)
    v_mfma_f32_16x16x32_bf16 v[92:95], v[44:47], v[16:19], 0
    s_waitcnt vmcnt(6)
    v_mfma_f32_16x16x32_bf16 v[92:95], v[48:51], v[16:19], v[92:95]
    s_waitcnt vmcnt(5)
    v_mfma_f32_16x16x32_bf16 v[92:95], v[52:55], v[16:19], v[92:95]
    s_waitcnt vmcnt(4)
    v_mfma_f32_16x16x32_bf16 v[92:95], v[56:59], v[16:19], v[92:95]
    s_waitcnt vmcnt(3)
    v_mfma_f32_16x16x32_bf16 v[92:95], v[60:63], v[16:19], v[92:95]
    s_waitcnt vmcnt(2)
    v_mfma_f32_16x16x32_bf16 v[92:95], v[64:67], v[16:19], v[92:95]
    s_waitcnt vmcnt(1)
    v_mfma_f32_16x16x32_bf16 v[92:95], v[68:71], v[16:19], v[92:95]
    s_waitcnt vmcnt(0)
    v_mfma_f32_16x16x32_bf16 v[92:95], v[72:75], v[16:19], v[92:95]
    v_bitop3_b32 v45, v44, v48, s33 bitop3:0x7e
    v_bitop3_b32 v46, v52, v56, s33 bitop3:0x7e
    v_bitop3_b32 v47, v60, v64, s33 bitop3:0x7e
    v_bitop3_b32 v49, v68, v72, s33 bitop3:0x7e
    v_or3_b32 v9, v45, v46, v47
    v_bitop3_b32 v9, v9, v49, 1 bitop3:0xa8
    v_cmp_ne_u32 vcc, 0, v9
    s_nop 0
    v_cvt_pk_bf16_f32 v92, v92, v93
    v_cvt_pk_bf16_f32 v93, v94, v95
    v_and_or_b32 v92, v92, -2, s33
    s_cbranch_vccnz L_rm1
    s_mov_b64 exec, s[42:43]
    buffer_store_dwordx2 v[92:93], v8, s[4:7], s38 offen sc0 sc1
    s_mov_b64 exec, -1
    v_mov_b32 v94, s23
    v_mov_b32 v95, s23
    s_bitcmp1_b32 s24, 2
    s_cbranch_scc1 L_b4m1
    s_nop 15
    s_nop 1
L_b4m1:
    s_barrier
    s_cmp_lg_u32 s31, 63
    s_cbranch_scc1 L_topm1
L_finm1:
    s_cmp_lg_u32 s20, 0
    s_cbranch_scc1 L_end
    v_lshlrev_b32 v9, 1, v8
    s_mov_b64 exec, s[42:43]
    buffer_store_dwordx4 v[92:95], v9, s[4:7], s46 offen sc0 sc1
    s_mov_b64 exec, -1
    s_branch L_end
L_end:
    s_endpgm

.section .rodata,"a"
.p2align 6
.amdhsa_kernel concat_heads__memory_aug_recurrent_mem_tr__ssm_conv_h3__prompt_kernel
  .amdhsa_next_free_vgpr 512
  .amdhsa_next_free_sgpr 102
  .amdhsa_accum_offset 256
  .amdhsa_group_segment_fixed_size 0
  .amdhsa_kernarg_size 128
  .amdhsa_user_sgpr_count 2
  .amdhsa_user_sgpr_kernarg_segment_ptr 1
  .amdhsa_system_sgpr_workgroup_id_x 1
.end_amdhsa_kernel
```
